```python
import torch

def _softmax(x, axis=-1):
    return torch.softmax(x, dim=axis)
def _gelu(x):
    return torch.nn.functional.gelu(x, approximate="tanh")
def _silu(x):
    return torch.nn.functional.silu(x)
def _sigmoid(x):
    return torch.sigmoid(x)
def _layernorm(x, axis=-1, eps=1e-5):
    m = x.mean(dim=axis, keepdim=True)
    v = x.var(dim=axis, keepdim=True, unbiased=False)
    return (x - m) / torch.sqrt(v + eps)
def _scatter_add(tgt, idx, src, axis=0):
    return tgt.clone().index_add_(axis, idx, src)
def _segment_sum(src, seg, n):
    out = torch.zeros((n,) + src.shape[1:], dtype=src.dtype)
    return out.index_add_(0, seg, src)
def _pad(x, pw):
    flat = tuple(v for pair in reversed(pw) for v in pair)
    return torch.nn.functional.pad(x, flat)

kernel_name = 'gated_mix__ssm_conv_s4__mha_block__prompt'

def setup_inputs():

    _w = (lambda a: (lambda t: t.to(torch.bfloat16) if t.is_floating_point() else t)(torch.as_tensor(a)))
    def _A_setup():
        B, L, D, N = 1, 2048, 512, 128
        A_re = -(lambda _x: torch.exp(torch.as_tensor(_x)))((lambda *s: torch.randn(*s, dtype=torch.bfloat16) * 6.4)(D, N))
        A_im = torch.pi * (lambda *s: torch.randn(*s, dtype=torch.bfloat16) * 0.1)(D, N)
        B_re = (lambda *s: torch.randn(*s, dtype=torch.bfloat16) * 0.2)(D, N)
        B_im = (lambda *s: torch.randn(*s, dtype=torch.bfloat16) * 0.2)(D, N)
        C_re = (lambda *s: torch.randn(*s, dtype=torch.bfloat16) * 0.2)(D, N)
        C_im = (lambda *s: torch.randn(*s, dtype=torch.bfloat16) * 0.2)(D, N)
        log_dt = (lambda *s: torch.randn(*s, dtype=torch.bfloat16) * 0.1)(D) * 0.5 - 4.0
        Dskip = (lambda *s: torch.randn(*s, dtype=torch.bfloat16) * 0.1)(D)
        return {
            "u": _w((lambda *s: torch.randn(*s, dtype=torch.bfloat16) * 0.05)(B, L, D)),
            "A_re": _w(A_re),
            "A_im": _w(A_im),
            "B_re": _w(B_re),
            "B_im": _w(B_im),
            "C_re": _w(C_re),
            "C_im": _w(C_im),
            "log_dt": _w(log_dt),
            "Dskip": _w(Dskip),
        }
    _A_in = _A_setup()

    def _B_setup():
        B, S, D, H = 1, 2048, 512, 32
        return {
            "x": _w((lambda *s: torch.randn(*s, dtype=torch.bfloat16) * 0.05)(B, S, D)),
            "wqkv": _w((lambda *s: torch.randn(*s, dtype=torch.bfloat16) * 0.8)(D, 3 * D)),
            "wo": _w((lambda *s: torch.randn(*s, dtype=torch.bfloat16) * 0.05)(D, D)),
        }
    _B_in = _B_setup()

    return {
        "A_u": _A_in["u"],
        "A_A_re": _A_in["A_re"],
        "A_A_im": _A_in["A_im"],
        "A_B_re": _A_in["B_re"],
        "A_B_im": _A_in["B_im"],
        "A_C_re": _A_in["C_re"],
        "A_C_im": _A_in["C_im"],
        "A_log_dt": _A_in["log_dt"],
        "A_Dskip": _A_in["Dskip"],
        "B_x": _B_in["x"],
        "B_wqkv": _B_in["wqkv"],
        "B_wo": _B_in["wo"],
        "gate_w": _w((lambda *s: torch.randn(*s, dtype=torch.bfloat16) * 0.05)(512) * 16.0),
    }

def reference(A_u, A_A_re, A_A_im, A_B_re, A_B_im, A_C_re, A_C_im, A_log_dt, A_Dskip, B_x, B_wqkv, B_wo, gate_w):
    def _A_ref(u, A_re, A_im, B_re, B_im, C_re, C_im, log_dt, Dskip):
        Bsz, L, D = u.shape
        dt = torch.exp(log_dt)[:, None]
        A = A_re + 1j * A_im
        Bc = B_re + 1j * B_im
        Cc = C_re + 1j * C_im
        logdA = dt * A
        dB = dt * Bc
        l = (lambda x, dt: x.to(dt))(torch.arange(L), A_re.dtype)
        P = torch.exp(logdA[:, :, None] * l[None, None, :])
        K = torch.einsum("dn,dnl,dn->dl", Cc, P, dB).real
        L2 = 2 * L
        Kp = _pad(K, ((0, 0), (0, L)))
        up = (lambda x, *d: x.permute(*d))(u, 0, 2, 1)
        up = _pad(up, ((0, 0), (0, 0), (0, L)))
        Kf = (lambda x, axes=(-2,-1): torch.fft.rfft2(x.float(), dim=axes))(Kp[:, None, :], axes=(-2, -1))
        Uf = (lambda x, axes=(-2,-1): torch.fft.rfft2(x.float(), dim=axes))(up[:, :, None, :], axes=(-2, -1))
        Yf = Uf * Kf[None, :, :, :]
        y = (lambda x, s, axes=(-2,-1): torch.fft.irfft2(x, s=s, dim=axes).to(torch.bfloat16))(Yf, (1, L2), axes=(-2, -1))[:, :, 0, :L]
        y = (lambda x, *d: x.permute(*d))(y, 0, 2, 1) + u * Dskip[None, None, :]
        return y

    def _B_ref(x, wqkv, wo):
        B, S, D = x.shape
        H = 32
        Dh = D // H
        qkv = (lambda x, *d: x.permute(*d))((x @ wqkv).reshape(B, S, 3, H, Dh), 2, 0, 3, 1, 4)
        q, k, v = qkv[0], qkv[1], qkv[2]
        scores = torch.einsum("bhqd,bhkd->bhqk", q, k) * (Dh ** -0.5)
        p = _softmax(scores, axis=-1)
        o = torch.einsum("bhqk,bhkd->bhqd", p, v)
        return (lambda x, *d: x.permute(*d))(o, 0, 2, 1, 3).reshape(B, S, D) @ wo

    x = A_u
    g = _sigmoid((x * gate_w).sum(-1, keepdims=True))
    a = _A_ref(x, A_A_re, A_A_im, A_B_re, A_B_im, A_C_re, A_C_im, A_log_dt, A_Dskip)
    b = _B_ref(x, B_wqkv, B_wo)
    return g * a + (1 - g) * b
```

```asm
; @launch grid=(256,1,1) block=(512,1,1) lds=163840
.amdgcn_target "amdgcn-amd-amdhsa--gfx950"
.text
.globl gated_mix__ssm_conv_s4__mha_block__prompt_kernel
.p2align 8
.type gated_mix__ssm_conv_s4__mha_block__prompt_kernel,@function
gated_mix__ssm_conv_s4__mha_block__prompt_kernel:
    s_cmp_ge_u32 s2, 256
    s_cbranch_scc1 L_end
    s_load_dwordx16 s[16:31], s[0:1], 0
    s_load_dwordx16 s[32:47], s[0:1], 64
    s_getpc_b64 s[12:13]
L_pc:
    v_lshrrev_b32 v1, 6, v0
    s_and_b32 s9, s2, 0xf8
    v_and_b32 v2, 32, v0
    v_lshl_add_u32 v2, v2, 3, v1
    v_add_lshl_u32 v2, v2, s9, 7
    v_min_u32 v2, L_end-L_pc, v2
    global_load_dword v2, v2, s[12:13]
    v_readfirstlane_b32 s3, v1
    v_and_b32 v0, 63, v0
    s_and_b32 s8, s2, 7
    s_lshr_b32 s9, s2, 3
    s_and_b32 s10, s8, 0
    s_lshl_b32 s10, s10, 3
    s_and_b32 s11, s9, 7
    s_or_b32 s4, s10, s11
    s_lshr_b32 s10, s8, 0
    s_lshl_b32 s10, s10, 2
    s_lshr_b32 s11, s9, 3
    s_or_b32 s5, s10, s11
    s_lshl_b32 s7, s4, 5
    s_or_b32 s7, s7, s5
    s_and_b32 s79, s3, 3
    s_lshr_b32 s82, s3, 2
    s_cbranch_scc0 L_common
    s_setprio 3
    s_lshl_b32 s8, s7, 2
    s_add_u32 s8, s8, s79
    s_lshl_b32 s9, s8, 7
    s_and_b32 s8, s8, -2
    v_lshl_add_u32 v1, v0, 1, s9
    v_mov_b32 v12, s8
    s_waitcnt lgkmcnt(0)
    global_load_ushort v26, v12, s[30:31]
    global_load_ushort v20, v1, s[18:19]
    global_load_ushort v21, v1, s[20:21]
    s_barrier
    global_load_ushort v22, v1, s[22:23]
    global_load_ushort v23, v1, s[24:25]
    global_load_ushort v24, v1, s[26:27]
    global_load_ushort v25, v1, s[28:29]
    global_load_ushort v27, v12, s[32:33]
L_common:
    s_add_u32 s6, s4, s5
    s_lshr_b32 s6, s5, 2
    s_add_u32 s6, s6, s4
    s_and_b32 s6, s6, 7
    v_lshrrev_b32 v1, 3, v0
    v_lshrrev_b32 v14, 4, v0
    v_and_b32 v12, 7, v0
    v_xor_b32 v13, v12, v14
    v_lshlrev_b32 v13, 4, v13
    v_lshl_add_u32 v4, v1, 10, v13
    v_xor_b32 v5, 64, v4
    v_add_u32 v5, 7168, v5
    v_and_b32 v14, 1, v14
    v_lshlrev_b32 v14, 1, v14
    v_xor_b32 v13, v12, v14
    v_lshlrev_b32 v13, 4, v13
    v_mul_u32_u24 v6, 3072, v1
    v_add_u32 v6, v6, v13
    v_xor_b32 v7, 64, v6
    v_add_u32 v7, 23552, v7
    s_and_b32 s80, s3, 1
    s_lshr_b32 s81, s79, 1
    v_lshrrev_b32 v1, 2, v0
    v_mul_u32_u24 v1, 3072, v1
    v_and_b32 v12, 3, v0
    v_lshl_add_u32 v1, v12, 4, v1
    v_and_b32 v12, 32, v0
    v_xor_b32 v136, v1, v12
    s_lshl_b32 s72, s79, 11
    s_lshl_b32 s68, s79, 12
    s_lshl_b32 s69, s79, 10
    s_lshr_b32 s73, s5, 1
    s_lshl_b32 s73, s73, 2
    s_add_u32 s73, s73, s79
    s_lshl_b32 s73, s73, 15
    s_mul_i32 s74, s79, 49152
    s_lshl_b32 s8, s4, 7
    s_add_u32 s74, s74, s8
    s_and_b32 s71, s5, 1
    s_mul_i32 s8, s71, 1152
    s_add_u32 s8, s8, 1152
    s_xor_b32 s70, s74, s8
    s_lshl_b32 s8, s71, 6
    s_add_u32 s74, s74, s8
    s_waitcnt lgkmcnt(0)
    s_mov_b32 s48, s16
    s_and_b32 s49, s17, 0xffff
    s_mov_b32 s50, 0x200000
    s_mov_b32 s51, 0x20000
    s_mov_b32 s52, s36
    s_and_b32 s53, s37, 0xffff
    s_mov_b32 s54, 0x180000
    s_mov_b32 s55, 0x20000
    s_cmp_lg_u32 s82, 0
    s_cbranch_scc1 L_ssm
    s_barrier
    s_add_u32 m0, s72, 81920
    s_add_u32 s78, s6, 0
    s_and_b32 s78, s78, 7
    s_mul_i32 s76, s78, 196608
    s_add_u32 s77, s76, s70
    buffer_load_dwordx4 v6, s[52:55], s77 offen offset:0 lds
    buffer_load_dwordx4 v7, s[52:55], s77 offen offset:1024 lds
    s_add_u32 m0, s69, 90112
    s_add_u32 s76, s76, s74
    buffer_load_dwordx4 v136, s[52:55], s76 offen offset:0 lds
    s_add_u32 m0, s68, 65536
    s_lshl_b32 s75, s78, 7
    s_add_u32 s75, s75, s73
    buffer_load_dwordx4 v4, s[48:51], s75 offen offset:0 lds
    buffer_load_dwordx4 v5, s[48:51], s75 offen offset:1024 lds
    s_add_u32 s75, s75, 14336
    buffer_load_dwordx4 v4, s[48:51], s75 offen offset:2048 lds
    buffer_load_dwordx4 v5, s[48:51], s75 offen offset:3072 lds
    v_lshrrev_b32 v22, 4, v0
    s_lshl_b32 s8, s6, 7
    v_lshl_add_u32 v1, v22, 4, s8
    global_load_dwordx4 v[240:243], v1, s[40:41] offset:0
    global_load_dwordx4 v[244:247], v1, s[40:41] offset:64
    s_add_u32 s94, s46, 11018240
    s_addc_u32 s95, s47, 0
    s_load_dword s96, s[94:95], 0
    s_getreg_b32 s97, hwreg(HW_REG_XCC_ID, 0, 4)
    s_mov_b32 s56, s46
    s_and_b32 s57, s47, 0xffff
    s_mov_b32 s58, 0xf00000
    s_mov_b32 s59, 0x20000
    s_mov_b32 s60, s38
    s_and_b32 s61, s39, 0xffff
    s_mov_b32 s62, 0x80000
    s_mov_b32 s63, 0x20000
    s_mov_b32 s64, s42
    s_and_b32 s65, s43, 0xffff
    s_mov_b32 s66, 0x200000
    s_mov_b32 s67, 0x20000
    v_and_b32 v1, 15, v0
    v_bfe_u32 v14, v0, 1, 3
    v_xor_b32 v14, v14, v22
    v_lshlrev_b32 v14, 4, v14
    v_lshl_add_u32 v14, v1, 7, v14
    v_add_u32 v24, s68, v14
    v_xor_b32 v25, 64, v24
    v_xor_b32 v26, 0x1000, v24
    v_xor_b32 v27, 0x1000, v25
    v_add_u32 v28, 65536, v24
    v_add_u32 v29, 65536, v25
    v_add_u32 v30, 65536, v26
    v_add_u32 v31, 65536, v27
    v_bfe_u32 v14, v0, 2, 2
    v_lshl_add_u32 v14, v22, 3, v14
    v_and_b32 v21, 3, v0
    v_lshlrev_b32 v21, 3, v21
    v_and_b32 v19, 16, v0
    v_lshl_add_u32 v16, v14, 6, v21
    v_lshl_add_u32 v16, v19, 1, v16
    s_lshl_b32 s8, s80, 5
    v_xor_b32 v16, s8, v16
    v_add_u32 v17, 65536, v16
    v_lshl_add_u32 v14, v14, 7, v21
    v_and_b32 v19, 24, v0
    v_lshl_add_u32 v8, v19, 2, v14
    s_lshl_b32 s8, s80, 6
    v_xor_b32 v8, s8, v8
    v_xor_b32 v9, 32, v8
    v_add_u32 v10, 65536, v8
    v_add_u32 v11, 65536, v9
    v_lshlrev_b32 v18, 4, v0
    v_and_b32 v14, 16, v0
    v_lshrrev_b32 v19, 1, v0
    v_and_b32 v19, 16, v19
    v_sub_u32 v14, v14, v19
    v_lshlrev_b32 v14, 4, v14
    v_mul_lo_u32 v14, v14, s71
    v_add_u32 v18, v18, v14
    v_and_b32 v1, 31, v0
    v_lshlrev_b32 v20, 2, v1
    v_mov_b32 v248, 0
    v_mov_b32 v249, 0
    s_mul_i32 s8, s71, 3
    s_xor_b32 s8, s8, 1
    s_xor_b32 s8, s8, s4
    s_lshl_b32 s8, s8, 19
    s_lshr_b32 s9, s73, 4
    s_add_u32 s8, s8, s9
    s_lshl_b32 s9, s71, 10
    s_add_u32 s8, s8, s9
    s_lshl_b32 s9, s80, 18
    s_add_u32 s8, s8, s9
    s_add_u32 s83, s8, 2228224
    s_xor_b32 s84, s83, 2048
    s_add_u32 s85, s83, 0x20000
    s_add_u32 s86, s84, 0x20000
    s_lshl_b32 s9, s5, 1
    s_add_u32 s9, s9, s80
    s_mul_i32 s12, s7, 128
    s_add_u32 s12, s12, 12582912
    s_lshl_b32 s13, s9, 10
    s_lshl_b32 s14, s4, 7
    s_add_u32 s13, s13, s14
    s_add_u32 s13, s13, 11206656
    s_lshl_b32 s14, s9, 7
    s_lshl_b32 s15, s4, 3
    s_add_u32 s14, s14, s15
    s_add_u32 s14, s14, 11026432
    s_lshl_b32 s8, s80, 12
    s_add_u32 s8, s8, s69
    s_xor_b32 s9, s8, 1024
    s_add_u32 s8, s8, 143872
    s_add_u32 s9, s9, 143872
    v_lshl_add_u32 v22, v0, 4, s8
    v_lshl_add_u32 v23, v0, 4, s9
    s_xor_b32 s101, s71, s81
    s_mov_b32 s15, 0x3eb8aa3b
    s_add_u32 m0, s72, 114688
    s_add_u32 s78, s6, 1
    s_and_b32 s78, s78, 7
    s_mul_i32 s76, s78, 196608
    s_add_u32 s77, s76, s70
    buffer_load_dwordx4 v6, s[52:55], s77 offen offset:0 lds
    buffer_load_dwordx4 v7, s[52:55], s77 offen offset:1024 lds
    s_add_u32 m0, s69, 122880
    s_add_u32 s76, s76, s74
    buffer_load_dwordx4 v136, s[52:55], s76 offen offset:0 lds
    s_add_u32 m0, s68, 98304
    s_lshl_b32 s75, s78, 7
    s_add_u32 s75, s75, s73
    buffer_load_dwordx4 v4, s[48:51], s75 offen offset:0 lds
    buffer_load_dwordx4 v5, s[48:51], s75 offen offset:1024 lds
    s_add_u32 s75, s75, 14336
    buffer_load_dwordx4 v4, s[48:51], s75 offen offset:2048 lds
    buffer_load_dwordx4 v5, s[48:51], s75 offen offset:3072 lds
    s_lshr_b32 s8, s5, 2
    s_lshl_b32 s8, s8, 7
    s_add_u32 s8, s8, 11042816
    buffer_load_dword v2, off, s[56:59], s8 sc1
    s_waitcnt lgkmcnt(0)
    s_mul_i32 s96, s96, 0x9e3779b1
    s_add_u32 s96, s96, 0x7f4a7c15
    s_setprio 2
    s_cmp_lg_u32 s71, 0
    s_cbranch_scc1 L_el_1
    s_waitcnt vmcnt(10)
    s_barrier
    ds_read_b128 v[224:227], v28 offset:0
    ds_read_b64_tr_b16 v[176:177], v10 offset:16384
    ds_read_b64_tr_b16 v[178:179], v10 offset:16896
    ds_read_b128 v[228:231], v28 offset:2048
    ds_read_b128 v[168:171], v30 offset:0
    ds_read_b128 v[172:175], v30 offset:2048
    ds_read_b64_tr_b16 v[180:181], v11 offset:16384
    ds_read_b64_tr_b16 v[182:183], v11 offset:16896
    ds_read_b64_tr_b16 v[184:185], v17 offset:24576
    ds_read_b64_tr_b16 v[186:187], v17 offset:24832
    s_waitcnt lgkmcnt(7)
    v_mfma_f32_16x16x32_bf16 v[128:131], v[176:179], v[224:227], 0
    ds_read_b128 v[232:235], v29 offset:0
    ds_read_b64_tr_b16 v[208:209], v10 offset:20480
    s_waitcnt lgkmcnt(8)
    v_mfma_f32_16x16x32_bf16 v[132:135], v[176:179], v[228:231], 0
    ds_read_b64_tr_b16 v[210:211], v10 offset:20992
    ds_read_b128 v[236:239], v29 offset:2048
    s_waitcnt lgkmcnt(9)
    v_mfma_f32_16x16x32_bf16 v[136:139], v[176:179], v[168:171], 0
    ds_read_b128 v[200:203], v31 offset:0
    ds_read_b128 v[204:207], v31 offset:2048
    s_waitcnt lgkmcnt(10)
    v_mfma_f32_16x16x32_bf16 v[140:143], v[176:179], v[172:175], 0
    ds_read_b64_tr_b16 v[212:213], v11 offset:20480
    ds_read_b64_tr_b16 v[214:215], v11 offset:20992
    s_waitcnt lgkmcnt(10)
    v_mfma_f32_16x16x32_bf16 v[144:147], v[180:183], v[224:227], 0
    ds_read_b64_tr_b16 v[216:217], v17 offset:26624
    ds_read_b64_tr_b16 v[218:219], v17 offset:26880
    v_mfma_f32_16x16x32_bf16 v[148:151], v[180:183], v[228:231], 0
    v_mfma_f32_16x16x32_bf16 v[152:155], v[180:183], v[168:171], 0
    v_mfma_f32_16x16x32_bf16 v[156:159], v[180:183], v[172:175], 0
    s_waitcnt lgkmcnt(10)
    v_mfma_f32_16x16x32_bf16 v[32:35], v[184:187], v[224:227], 0
    v_mfma_f32_16x16x32_bf16 v[36:39], v[184:187], v[228:231], 0
    v_mfma_f32_16x16x32_bf16 v[40:43], v[184:187], v[168:171], 0
    v_mfma_f32_16x16x32_bf16 v[44:47], v[184:187], v[172:175], 0
    s_waitcnt lgkmcnt(7)
    v_mfma_f32_16x16x32_bf16 v[128:131], v[208:211], v[232:235], v[128:131]
    s_waitcnt vmcnt(1) lgkmcnt(0)
    s_barrier
    v_mfma_f32_16x16x32_bf16 v[132:135], v[208:211], v[236:239], v[132:135]
    ds_read_b128 v[160:163], v28 offset:32768
    ds_read_b64_tr_b16 v[176:177], v10 offset:49152
    v_mfma_f32_16x16x32_bf16 v[136:139], v[208:211], v[200:203], v[136:139]
    ds_read_b64_tr_b16 v[178:179], v10 offset:49664
    ds_read_b128 v[164:167], v28 offset:34816
    v_mfma_f32_16x16x32_bf16 v[140:143], v[208:211], v[204:207], v[140:143]
    ds_read_b128 v[168:171], v30 offset:32768
    ds_read_b128 v[172:175], v30 offset:34816
    v_mfma_f32_16x16x32_bf16 v[144:147], v[212:215], v[232:235], v[144:147]
    ds_read_b64_tr_b16 v[180:181], v11 offset:49152
    ds_read_b64_tr_b16 v[182:183], v11 offset:49664
    v_mfma_f32_16x16x32_bf16 v[148:151], v[212:215], v[236:239], v[148:151]
    ds_read_b64_tr_b16 v[184:185], v17 offset:57344
    ds_read_b64_tr_b16 v[186:187], v17 offset:57600
    v_mfma_f32_16x16x32_bf16 v[152:155], v[212:215], v[200:203], v[152:155]
    v_mfma_f32_16x16x32_bf16 v[156:159], v[212:215], v[204:207], v[156:159]
    v_mfma_f32_16x16x32_bf16 v[32:35], v[216:219], v[232:235], v[32:35]
    v_mfma_f32_16x16x32_bf16 v[36:39], v[216:219], v[236:239], v[36:39]
    v_mfma_f32_16x16x32_bf16 v[40:43], v[216:219], v[200:203], v[40:43]
    v_mfma_f32_16x16x32_bf16 v[44:47], v[216:219], v[204:207], v[44:47]
    s_waitcnt lgkmcnt(7)
    v_mfma_f32_16x16x32_bf16 v[128:131], v[176:179], v[160:163], v[128:131]
    ds_read_b128 v[192:195], v29 offset:32768
    ds_read_b64_tr_b16 v[208:209], v10 offset:53248
    s_waitcnt lgkmcnt(8)
    v_mfma_f32_16x16x32_bf16 v[132:135], v[176:179], v[164:167], v[132:135]
    ds_read_b64_tr_b16 v[210:211], v10 offset:53760
    ds_read_b128 v[196:199], v29 offset:34816
    s_waitcnt lgkmcnt(9)
    v_mfma_f32_16x16x32_bf16 v[136:139], v[176:179], v[168:171], v[136:139]
    ds_read_b128 v[200:203], v31 offset:32768
    ds_read_b128 v[204:207], v31 offset:34816
    s_waitcnt lgkmcnt(10)
    v_mfma_f32_16x16x32_bf16 v[140:143], v[176:179], v[172:175], v[140:143]
    ds_read_b64_tr_b16 v[212:213], v11 offset:53248
    ds_read_b64_tr_b16 v[214:215], v11 offset:53760
    s_waitcnt lgkmcnt(10)
    v_mfma_f32_16x16x32_bf16 v[144:147], v[180:183], v[160:163], v[144:147]
    ds_read_b64_tr_b16 v[216:217], v17 offset:59392
    ds_read_b64_tr_b16 v[218:219], v17 offset:59648
    v_mfma_f32_16x16x32_bf16 v[148:151], v[180:183], v[164:167], v[148:151]
    v_mfma_f32_16x16x32_bf16 v[152:155], v[180:183], v[168:171], v[152:155]
    v_mfma_f32_16x16x32_bf16 v[156:159], v[180:183], v[172:175], v[156:159]
    s_waitcnt lgkmcnt(10)
    v_mfma_f32_16x16x32_bf16 v[32:35], v[184:187], v[160:163], v[32:35]
    v_mfma_f32_16x16x32_bf16 v[36:39], v[184:187], v[164:167], v[36:39]
    v_mfma_f32_16x16x32_bf16 v[40:43], v[184:187], v[168:171], v[40:43]
    v_mfma_f32_16x16x32_bf16 v[44:47], v[184:187], v[172:175], v[44:47]
    s_waitcnt lgkmcnt(7)
    v_mfma_f32_16x16x32_bf16 v[128:131], v[208:211], v[192:195], v[128:131]
    s_waitcnt lgkmcnt(0)
    s_barrier
    v_mfma_f32_16x16x32_bf16 v[132:135], v[208:211], v[196:199], v[132:135]
    ds_read_b128 v[160:163], v24 offset:0
    ds_read_b64_tr_b16 v[176:177], v8 offset:16384
    v_mfma_f32_16x16x32_bf16 v[136:139], v[208:211], v[200:203], v[136:139]
    ds_read_b64_tr_b16 v[178:179], v8 offset:16896
    ds_read_b128 v[164:167], v24 offset:2048
    v_mfma_f32_16x16x32_bf16 v[140:143], v[208:211], v[204:207], v[140:143]
    ds_read_b128 v[168:171], v26 offset:0
    ds_read_b128 v[172:175], v26 offset:2048
    v_mfma_f32_16x16x32_bf16 v[144:147], v[212:215], v[192:195], v[144:147]
    ds_read_b64_tr_b16 v[180:181], v9 offset:16384
    ds_read_b64_tr_b16 v[182:183], v9 offset:16896
    v_mfma_f32_16x16x32_bf16 v[148:151], v[212:215], v[196:199], v[148:151]
    ds_read_b64_tr_b16 v[184:185], v16 offset:24576
    ds_read_b64_tr_b16 v[186:187], v16 offset:24832
    v_mfma_f32_16x16x32_bf16 v[152:155], v[212:215], v[200:203], v[152:155]
    v_mfma_f32_16x16x32_bf16 v[156:159], v[212:215], v[204:207], v[156:159]
    v_mfma_f32_16x16x32_bf16 v[32:35], v[216:219], v[192:195], v[32:35]
    v_mfma_f32_16x16x32_bf16 v[36:39], v[216:219], v[196:199], v[36:39]
    v_mfma_f32_16x16x32_bf16 v[40:43], v[216:219], v[200:203], v[40:43]
    v_mfma_f32_16x16x32_bf16 v[44:47], v[216:219], v[204:207], v[44:47]
    s_waitcnt lgkmcnt(7)
    v_mfma_f32_16x16x32_bf16 v[128:131], v[176:179], v[160:163], v[128:131]
    ds_read_b128 v[192:195], v25 offset:0
    ds_read_b64_tr_b16 v[208:209], v8 offset:20480
    s_waitcnt lgkmcnt(8)
    v_mfma_f32_16x16x32_bf16 v[132:135], v[176:179], v[164:167], v[132:135]
    ds_read_b64_tr_b16 v[210:211], v8 offset:20992
    ds_read_b128 v[196:199], v25 offset:2048
    s_waitcnt lgkmcnt(9)
    v_mfma_f32_16x16x32_bf16 v[136:139], v[176:179], v[168:171], v[136:139]
    ds_read_b128 v[200:203], v27 offset:0
    ds_read_b128 v[204:207], v27 offset:2048
    s_waitcnt lgkmcnt(10)
    v_mfma_f32_16x16x32_bf16 v[140:143], v[176:179], v[172:175], v[140:143]
    ds_read_b64_tr_b16 v[212:213], v9 offset:20480
    ds_read_b64_tr_b16 v[214:215], v9 offset:20992
    s_waitcnt lgkmcnt(10)
    v_mfma_f32_16x16x32_bf16 v[144:147], v[180:183], v[160:163], v[144:147]
    ds_read_b64_tr_b16 v[216:217], v16 offset:26624
    ds_read_b64_tr_b16 v[218:219], v16 offset:26880
    v_mfma_f32_16x16x32_bf16 v[148:151], v[180:183], v[164:167], v[148:151]
    v_mfma_f32_16x16x32_bf16 v[152:155], v[180:183], v[168:171], v[152:155]
    v_mfma_f32_16x16x32_bf16 v[156:159], v[180:183], v[172:175], v[156:159]
    s_waitcnt lgkmcnt(10)
    v_mfma_f32_16x16x32_bf16 v[32:35], v[184:187], v[160:163], v[32:35]
    v_mfma_f32_16x16x32_bf16 v[36:39], v[184:187], v[164:167], v[36:39]
    v_mfma_f32_16x16x32_bf16 v[40:43], v[184:187], v[168:171], v[40:43]
    v_mfma_f32_16x16x32_bf16 v[44:47], v[184:187], v[172:175], v[44:47]
    s_waitcnt lgkmcnt(7)
    v_mfma_f32_16x16x32_bf16 v[128:131], v[208:211], v[192:195], v[128:131]
    s_waitcnt vmcnt(0) lgkmcnt(0)
    s_barrier
    v_mfma_f32_16x16x32_bf16 v[132:135], v[208:211], v[196:199], v[132:135]
    ds_read_b128 v[160:163], v24 offset:32768
    ds_read_b64_tr_b16 v[176:177], v8 offset:49152
    v_mfma_f32_16x16x32_bf16 v[136:139], v[208:211], v[200:203], v[136:139]
    ds_read_b64_tr_b16 v[178:179], v8 offset:49664
    ds_read_b128 v[164:167], v24 offset:34816
    v_mfma_f32_16x16x32_bf16 v[140:143], v[208:211], v[204:207], v[140:143]
    ds_read_b128 v[168:171], v26 offset:32768
    ds_read_b128 v[172:175], v26 offset:34816
    v_mfma_f32_16x16x32_bf16 v[144:147], v[212:215], v[192:195], v[144:147]
    ds_read_b64_tr_b16 v[180:181], v9 offset:49152
    ds_read_b64_tr_b16 v[182:183], v9 offset:49664
    v_mfma_f32_16x16x32_bf16 v[148:151], v[212:215], v[196:199], v[148:151]
    ds_read_b64_tr_b16 v[184:185], v16 offset:57344
    ds_read_b64_tr_b16 v[186:187], v16 offset:57600
    v_mfma_f32_16x16x32_bf16 v[152:155], v[212:215], v[200:203], v[152:155]
    v_mfma_f32_16x16x32_bf16 v[156:159], v[212:215], v[204:207], v[156:159]
    v_mfma_f32_16x16x32_bf16 v[32:35], v[216:219], v[192:195], v[32:35]
    v_mfma_f32_16x16x32_bf16 v[36:39], v[216:219], v[196:199], v[36:39]
    v_mfma_f32_16x16x32_bf16 v[40:43], v[216:219], v[200:203], v[40:43]
    v_mfma_f32_16x16x32_bf16 v[44:47], v[216:219], v[204:207], v[44:47]
    s_waitcnt lgkmcnt(7)
    v_mfma_f32_16x16x32_bf16 v[128:131], v[176:179], v[160:163], v[128:131]
    ds_read_b128 v[192:195], v25 offset:32768
    ds_read_b64_tr_b16 v[208:209], v8 offset:53248
    s_waitcnt lgkmcnt(8)
    v_mfma_f32_16x16x32_bf16 v[132:135], v[176:179], v[164:167], v[132:135]
    ds_read_b64_tr_b16 v[210:211], v8 offset:53760
    ds_read_b128 v[196:199], v25 offset:34816
    s_waitcnt lgkmcnt(9)
    v_mfma_f32_16x16x32_bf16 v[136:139], v[176:179], v[168:171], v[136:139]
    ds_read_b128 v[200:203], v27 offset:32768
    ds_read_b128 v[204:207], v27 offset:34816
    s_waitcnt lgkmcnt(10)
    v_mfma_f32_16x16x32_bf16 v[140:143], v[176:179], v[172:175], v[140:143]
    ds_read_b64_tr_b16 v[212:213], v9 offset:53248
    ds_read_b64_tr_b16 v[214:215], v9 offset:53760
    s_waitcnt lgkmcnt(10)
    v_mfma_f32_16x16x32_bf16 v[144:147], v[180:183], v[160:163], v[144:147]
    ds_read_b64_tr_b16 v[216:217], v16 offset:59392
    ds_read_b64_tr_b16 v[218:219], v16 offset:59648
    v_mfma_f32_16x16x32_bf16 v[148:151], v[180:183], v[164:167], v[148:151]
    v_mfma_f32_16x16x32_bf16 v[152:155], v[180:183], v[168:171], v[152:155]
    v_mfma_f32_16x16x32_bf16 v[156:159], v[180:183], v[172:175], v[156:159]
    s_waitcnt lgkmcnt(10)
    v_mfma_f32_16x16x32_bf16 v[32:35], v[184:187], v[160:163], v[32:35]
    v_mfma_f32_16x16x32_bf16 v[36:39], v[184:187], v[164:167], v[36:39]
    v_mfma_f32_16x16x32_bf16 v[40:43], v[184:187], v[168:171], v[40:43]
    v_mfma_f32_16x16x32_bf16 v[44:47], v[184:187], v[172:175], v[44:47]
    s_waitcnt lgkmcnt(7)
    v_mfma_f32_16x16x32_bf16 v[128:131], v[208:211], v[192:195], v[128:131]
    s_waitcnt lgkmcnt(0)
    s_barrier
    v_mfma_f32_16x16x32_bf16 v[132:135], v[208:211], v[196:199], v[132:135]
    ds_read_b128 v[160:163], v28 offset:0
    ds_read_b64_tr_b16 v[176:177], v10 offset:16384
    v_mfma_f32_16x16x32_bf16 v[136:139], v[208:211], v[200:203], v[136:139]
    ds_read_b64_tr_b16 v[178:179], v10 offset:16896
    ds_read_b128 v[164:167], v28 offset:2048
    v_mfma_f32_16x16x32_bf16 v[140:143], v[208:211], v[204:207], v[140:143]
    ds_read_b128 v[168:171], v30 offset:0
    ds_read_b128 v[172:175], v30 offset:2048
    v_mfma_f32_16x16x32_bf16 v[144:147], v[212:215], v[192:195], v[144:147]
    ds_read_b64_tr_b16 v[180:181], v11 offset:16384
    ds_read_b64_tr_b16 v[182:183], v11 offset:16896
    v_mfma_f32_16x16x32_bf16 v[148:151], v[212:215], v[196:199], v[148:151]
    ds_read_b64_tr_b16 v[184:185], v17 offset:24576
    ds_read_b64_tr_b16 v[186:187], v17 offset:24832
    v_mfma_f32_16x16x32_bf16 v[152:155], v[212:215], v[200:203], v[152:155]
    v_mfma_f32_16x16x32_bf16 v[156:159], v[212:215], v[204:207], v[156:159]
    v_mfma_f32_16x16x32_bf16 v[32:35], v[216:219], v[192:195], v[32:35]
    v_mfma_f32_16x16x32_bf16 v[36:39], v[216:219], v[196:199], v[36:39]
    v_mfma_f32_16x16x32_bf16 v[40:43], v[216:219], v[200:203], v[40:43]
    v_mfma_f32_16x16x32_bf16 v[44:47], v[216:219], v[204:207], v[44:47]
    s_waitcnt lgkmcnt(7)
    v_mfma_f32_16x16x32_bf16 v[128:131], v[176:179], v[160:163], v[128:131]
    ds_read_b128 v[192:195], v29 offset:0
    ds_read_b64_tr_b16 v[208:209], v10 offset:20480
    s_waitcnt lgkmcnt(8)
    v_mfma_f32_16x16x32_bf16 v[132:135], v[176:179], v[164:167], v[132:135]
    ds_read_b64_tr_b16 v[210:211], v10 offset:20992
    ds_read_b128 v[196:199], v29 offset:2048
    s_waitcnt lgkmcnt(9)
    v_mfma_f32_16x16x32_bf16 v[136:139], v[176:179], v[168:171], v[136:139]
    ds_read_b128 v[200:203], v31 offset:0
    ds_read_b128 v[204:207], v31 offset:2048
    s_waitcnt lgkmcnt(10)
    v_mfma_f32_16x16x32_bf16 v[140:143], v[176:179], v[172:175], v[140:143]
    ds_read_b64_tr_b16 v[212:213], v11 offset:20480
    ds_read_b64_tr_b16 v[214:215], v11 offset:20992
    s_waitcnt lgkmcnt(10)
    v_mfma_f32_16x16x32_bf16 v[144:147], v[180:183], v[160:163], v[144:147]
    ds_read_b64_tr_b16 v[216:217], v17 offset:26624
    ds_read_b64_tr_b16 v[218:219], v17 offset:26880
    v_mfma_f32_16x16x32_bf16 v[148:151], v[180:183], v[164:167], v[148:151]
    v_mfma_f32_16x16x32_bf16 v[152:155], v[180:183], v[168:171], v[152:155]
    v_mfma_f32_16x16x32_bf16 v[156:159], v[180:183], v[172:175], v[156:159]
    s_waitcnt lgkmcnt(10)
    v_mfma_f32_16x16x32_bf16 v[32:35], v[184:187], v[160:163], v[32:35]
    v_mfma_f32_16x16x32_bf16 v[36:39], v[184:187], v[164:167], v[36:39]
    v_mfma_f32_16x16x32_bf16 v[40:43], v[184:187], v[168:171], v[40:43]
    v_mfma_f32_16x16x32_bf16 v[44:47], v[184:187], v[172:175], v[44:47]
    s_waitcnt lgkmcnt(7)
    v_mfma_f32_16x16x32_bf16 v[128:131], v[208:211], v[192:195], v[128:131]
    s_waitcnt lgkmcnt(0)
    s_barrier
    v_mfma_f32_16x16x32_bf16 v[132:135], v[208:211], v[196:199], v[132:135]
    ds_read_b128 v[160:163], v28 offset:32768
    ds_read_b64_tr_b16 v[176:177], v10 offset:49152
    v_mfma_f32_16x16x32_bf16 v[136:139], v[208:211], v[200:203], v[136:139]
    ds_read_b64_tr_b16 v[178:179], v10 offset:49664
    ds_read_b128 v[164:167], v28 offset:34816
    v_mfma_f32_16x16x32_bf16 v[140:143], v[208:211], v[204:207], v[140:143]
    ds_read_b128 v[168:171], v30 offset:32768
    ds_read_b128 v[172:175], v30 offset:34816
    v_mfma_f32_16x16x32_bf16 v[144:147], v[212:215], v[192:195], v[144:147]
    ds_read_b64_tr_b16 v[180:181], v11 offset:49152
    ds_read_b64_tr_b16 v[182:183], v11 offset:49664
    v_mfma_f32_16x16x32_bf16 v[148:151], v[212:215], v[196:199], v[148:151]
    ds_read_b64_tr_b16 v[184:185], v17 offset:57344
    ds_read_b64_tr_b16 v[186:187], v17 offset:57600
    v_mfma_f32_16x16x32_bf16 v[152:155], v[212:215], v[200:203], v[152:155]
    v_mfma_f32_16x16x32_bf16 v[156:159], v[212:215], v[204:207], v[156:159]
    v_mfma_f32_16x16x32_bf16 v[32:35], v[216:219], v[192:195], v[32:35]
    v_mfma_f32_16x16x32_bf16 v[36:39], v[216:219], v[196:199], v[36:39]
    v_mfma_f32_16x16x32_bf16 v[40:43], v[216:219], v[200:203], v[40:43]
    v_mfma_f32_16x16x32_bf16 v[44:47], v[216:219], v[204:207], v[44:47]
    s_waitcnt lgkmcnt(7)
    v_mfma_f32_16x16x32_bf16 v[128:131], v[176:179], v[160:163], v[128:131]
    ds_read_b128 v[192:195], v29 offset:32768
    ds_read_b64_tr_b16 v[208:209], v10 offset:53248
    s_waitcnt lgkmcnt(8)
    v_mfma_f32_16x16x32_bf16 v[132:135], v[176:179], v[164:167], v[132:135]
    ds_read_b64_tr_b16 v[210:211], v10 offset:53760
    ds_read_b128 v[196:199], v29 offset:34816
    s_waitcnt lgkmcnt(9)
    v_mfma_f32_16x16x32_bf16 v[136:139], v[176:179], v[168:171], v[136:139]
    ds_read_b128 v[200:203], v31 offset:32768
    ds_read_b128 v[204:207], v31 offset:34816
    s_waitcnt lgkmcnt(10)
    v_mfma_f32_16x16x32_bf16 v[140:143], v[176:179], v[172:175], v[140:143]
    ds_read_b64_tr_b16 v[212:213], v11 offset:53248
    ds_read_b64_tr_b16 v[214:215], v11 offset:53760
    s_waitcnt lgkmcnt(10)
    v_mfma_f32_16x16x32_bf16 v[144:147], v[180:183], v[160:163], v[144:147]
    ds_read_b64_tr_b16 v[216:217], v17 offset:59392
    ds_read_b64_tr_b16 v[218:219], v17 offset:59648
    v_mfma_f32_16x16x32_bf16 v[148:151], v[180:183], v[164:167], v[148:151]
    v_mfma_f32_16x16x32_bf16 v[152:155], v[180:183], v[168:171], v[152:155]
    v_mfma_f32_16x16x32_bf16 v[156:159], v[180:183], v[172:175], v[156:159]
    s_waitcnt lgkmcnt(10)
    v_mfma_f32_16x16x32_bf16 v[32:35], v[184:187], v[160:163], v[32:35]
    v_mfma_f32_16x16x32_bf16 v[36:39], v[184:187], v[164:167], v[36:39]
    v_mfma_f32_16x16x32_bf16 v[40:43], v[184:187], v[168:171], v[40:43]
    v_mfma_f32_16x16x32_bf16 v[44:47], v[184:187], v[172:175], v[44:47]
    s_waitcnt lgkmcnt(7)
    v_mfma_f32_16x16x32_bf16 v[128:131], v[208:211], v[192:195], v[128:131]
    s_waitcnt lgkmcnt(0)
    s_barrier
    v_mfma_f32_16x16x32_bf16 v[132:135], v[208:211], v[196:199], v[132:135]
    ds_read_b128 v[48:51], v24 offset:0
    ds_read_b64_tr_b16 v[176:177], v8 offset:16384
    v_mfma_f32_16x16x32_bf16 v[136:139], v[208:211], v[200:203], v[136:139]
    ds_read_b64_tr_b16 v[178:179], v8 offset:16896
    ds_read_b128 v[52:55], v24 offset:2048
    v_mfma_f32_16x16x32_bf16 v[140:143], v[208:211], v[204:207], v[140:143]
    ds_read_b128 v[56:59], v26 offset:0
    ds_read_b128 v[60:63], v26 offset:2048
    v_mfma_f32_16x16x32_bf16 v[144:147], v[212:215], v[192:195], v[144:147]
    ds_read_b64_tr_b16 v[180:181], v9 offset:16384
    ds_read_b64_tr_b16 v[182:183], v9 offset:16896
    v_mfma_f32_16x16x32_bf16 v[148:151], v[212:215], v[196:199], v[148:151]
    v_mfma_f32_16x16x32_bf16 v[152:155], v[212:215], v[200:203], v[152:155]
    v_mfma_f32_16x16x32_bf16 v[156:159], v[212:215], v[204:207], v[156:159]
    v_mfma_f32_16x16x32_bf16 v[32:35], v[216:219], v[192:195], v[32:35]
    v_mfma_f32_16x16x32_bf16 v[36:39], v[216:219], v[196:199], v[36:39]
    v_mfma_f32_16x16x32_bf16 v[40:43], v[216:219], v[200:203], v[40:43]
    v_mfma_f32_16x16x32_bf16 v[44:47], v[216:219], v[204:207], v[44:47]
    s_waitcnt lgkmcnt(5)
    v_mfma_f32_16x16x32_bf16 v[128:131], v[176:179], v[48:51], v[128:131]
    ds_read_b128 v[64:67], v25 offset:0
    ds_read_b64_tr_b16 v[208:209], v8 offset:20480
    s_waitcnt lgkmcnt(6)
    v_mfma_f32_16x16x32_bf16 v[132:135], v[176:179], v[52:55], v[132:135]
    ds_read_b64_tr_b16 v[210:211], v8 offset:20992
    ds_read_b128 v[68:71], v25 offset:2048
    s_waitcnt lgkmcnt(7)
    v_mfma_f32_16x16x32_bf16 v[136:139], v[176:179], v[56:59], v[136:139]
    ds_read_b128 v[72:75], v27 offset:0
    ds_read_b128 v[76:79], v27 offset:2048
    s_waitcnt lgkmcnt(8)
    v_mfma_f32_16x16x32_bf16 v[140:143], v[176:179], v[60:63], v[140:143]
    ds_read_b64_tr_b16 v[212:213], v9 offset:20480
    ds_read_b64_tr_b16 v[214:215], v9 offset:20992
    s_waitcnt lgkmcnt(8)
    v_mfma_f32_16x16x32_bf16 v[144:147], v[180:183], v[48:51], v[144:147]
    v_mfma_f32_16x16x32_bf16 v[148:151], v[180:183], v[52:55], v[148:151]
    v_mfma_f32_16x16x32_bf16 v[152:155], v[180:183], v[56:59], v[152:155]
    v_mfma_f32_16x16x32_bf16 v[156:159], v[180:183], v[60:63], v[156:159]
    s_waitcnt lgkmcnt(5)
    v_mfma_f32_16x16x32_bf16 v[128:131], v[208:211], v[64:67], v[128:131]
    s_waitcnt lgkmcnt(0)
    s_barrier
    v_mfma_f32_16x16x32_bf16 v[132:135], v[208:211], v[68:71], v[132:135]
    ds_read_b128 v[80:83], v24 offset:32768
    ds_read_b64_tr_b16 v[176:177], v8 offset:49152
    v_mfma_f32_16x16x32_bf16 v[136:139], v[208:211], v[72:75], v[136:139]
    ds_read_b64_tr_b16 v[178:179], v8 offset:49664
    ds_read_b128 v[84:87], v24 offset:34816
    v_mfma_f32_16x16x32_bf16 v[140:143], v[208:211], v[76:79], v[140:143]
    ds_read_b128 v[88:91], v26 offset:32768
    ds_read_b128 v[92:95], v26 offset:34816
    v_mfma_f32_16x16x32_bf16 v[144:147], v[212:215], v[64:67], v[144:147]
    ds_read_b64_tr_b16 v[180:181], v9 offset:49152
    ds_read_b64_tr_b16 v[182:183], v9 offset:49664
    v_mfma_f32_16x16x32_bf16 v[148:151], v[212:215], v[68:71], v[148:151]
    ds_read_b128 v[96:99], v25 offset:32768
    ds_read_b64_tr_b16 v[192:193], v8 offset:53248
    v_mfma_f32_16x16x32_bf16 v[152:155], v[212:215], v[72:75], v[152:155]
    ds_read_b64_tr_b16 v[194:195], v8 offset:53760
    ds_read_b128 v[100:103], v25 offset:34816
    v_mfma_f32_16x16x32_bf16 v[156:159], v[212:215], v[76:79], v[156:159]
    ds_read_b128 v[104:107], v27 offset:32768
    ds_read_b128 v[108:111], v27 offset:34816
    s_waitcnt lgkmcnt(11)
    v_mfma_f32_16x16x32_bf16 v[128:131], v[176:179], v[80:83], v[128:131]
    ds_read_b64_tr_b16 v[196:197], v9 offset:53248
    ds_read_b64_tr_b16 v[198:199], v9 offset:53760
    s_waitcnt lgkmcnt(12)
    v_mfma_f32_16x16x32_bf16 v[132:135], v[176:179], v[84:87], v[132:135]
    s_waitcnt lgkmcnt(11)
    v_mfma_f32_16x16x32_bf16 v[136:139], v[176:179], v[88:91], v[136:139]
    s_waitcnt lgkmcnt(10)
    v_mfma_f32_16x16x32_bf16 v[140:143], v[176:179], v[92:95], v[140:143]
    s_waitcnt lgkmcnt(8)
    v_mfma_f32_16x16x32_bf16 v[144:147], v[180:183], v[80:83], v[144:147]
    v_mfma_f32_16x16x32_bf16 v[148:151], v[180:183], v[84:87], v[148:151]
    v_mfma_f32_16x16x32_bf16 v[152:155], v[180:183], v[88:91], v[152:155]
    v_mfma_f32_16x16x32_bf16 v[156:159], v[180:183], v[92:95], v[156:159]
    s_waitcnt lgkmcnt(5)
    v_mfma_f32_16x16x32_bf16 v[128:131], v[192:195], v[96:99], v[128:131]
    s_waitcnt lgkmcnt(0)
    s_barrier
    v_mfma_f32_16x16x32_bf16 v[132:135], v[192:195], v[100:103], v[132:135]
    ds_read_b64_tr_b16 v[112:113], v16 offset:24576
    ds_read_b64_tr_b16 v[114:115], v16 offset:24832
    v_mfma_f32_16x16x32_bf16 v[136:139], v[192:195], v[104:107], v[136:139]
    ds_read_b64_tr_b16 v[116:117], v16 offset:26624
    ds_read_b64_tr_b16 v[118:119], v16 offset:26880
    v_mfma_f32_16x16x32_bf16 v[140:143], v[192:195], v[108:111], v[140:143]
    ds_read_b64_tr_b16 v[120:121], v16 offset:57344
    ds_read_b64_tr_b16 v[122:123], v16 offset:57600
    v_mfma_f32_16x16x32_bf16 v[144:147], v[196:199], v[96:99], v[144:147]
    ds_read_b64_tr_b16 v[124:125], v16 offset:59392
    ds_read_b64_tr_b16 v[126:127], v16 offset:59648
    v_mfma_f32_16x16x32_bf16 v[148:151], v[196:199], v[100:103], v[148:151]
    v_mfma_f32_16x16x32_bf16 v[152:155], v[196:199], v[104:107], v[152:155]
    v_mfma_f32_16x16x32_bf16 v[156:159], v[196:199], v[108:111], v[156:159]
    s_branch L_fi_2
L_el_1:
    s_waitcnt vmcnt(10)
    s_barrier
    ds_read_b128 v[224:227], v28 offset:0
    ds_read_b64_tr_b16 v[176:177], v10 offset:16384
    ds_read_b64_tr_b16 v[178:179], v10 offset:16896
    ds_read_b128 v[228:231], v28 offset:2048
    ds_read_b128 v[168:171], v30 offset:0
    ds_read_b128 v[172:175], v30 offset:2048
    ds_read_b64_tr_b16 v[180:181], v11 offset:16384
    ds_read_b64_tr_b16 v[182:183], v11 offset:16896
    ds_read_b64_tr_b16 v[184:185], v17 offset:24576
    ds_read_b64_tr_b16 v[186:187], v17 offset:24832
    s_waitcnt lgkmcnt(7)
    v_mfma_f32_16x16x32_bf16 v[128:131], v[224:227], v[176:179], 0
    ds_read_b128 v[232:235], v29 offset:0
    ds_read_b64_tr_b16 v[208:209], v10 offset:20480
    s_waitcnt lgkmcnt(8)
    v_mfma_f32_16x16x32_bf16 v[132:135], v[228:231], v[176:179], 0
    ds_read_b64_tr_b16 v[210:211], v10 offset:20992
    ds_read_b128 v[236:239], v29 offset:2048
    s_waitcnt lgkmcnt(9)
    v_mfma_f32_16x16x32_bf16 v[136:139], v[168:171], v[176:179], 0
    ds_read_b128 v[200:203], v31 offset:0
    ds_read_b128 v[204:207], v31 offset:2048
    s_waitcnt lgkmcnt(10)
    v_mfma_f32_16x16x32_bf16 v[140:143], v[172:175], v[176:179], 0
    ds_read_b64_tr_b16 v[212:213], v11 offset:20480
    ds_read_b64_tr_b16 v[214:215], v11 offset:20992
    s_waitcnt lgkmcnt(10)
    v_mfma_f32_16x16x32_bf16 v[144:147], v[224:227], v[180:183], 0
    ds_read_b64_tr_b16 v[216:217], v17 offset:26624
    ds_read_b64_tr_b16 v[218:219], v17 offset:26880
    v_mfma_f32_16x16x32_bf16 v[148:151], v[228:231], v[180:183], 0
    v_mfma_f32_16x16x32_bf16 v[152:155], v[168:171], v[180:183], 0
    v_mfma_f32_16x16x32_bf16 v[156:159], v[172:175], v[180:183], 0
    s_waitcnt lgkmcnt(10)
    v_mfma_f32_16x16x32_bf16 v[32:35], v[184:187], v[224:227], 0
    v_mfma_f32_16x16x32_bf16 v[36:39], v[184:187], v[228:231], 0
    v_mfma_f32_16x16x32_bf16 v[40:43], v[184:187], v[168:171], 0
    v_mfma_f32_16x16x32_bf16 v[44:47], v[184:187], v[172:175], 0
    s_waitcnt lgkmcnt(7)
    v_mfma_f32_16x16x32_bf16 v[128:131], v[232:235], v[208:211], v[128:131]
    s_waitcnt vmcnt(1) lgkmcnt(0)
    s_barrier
    v_mfma_f32_16x16x32_bf16 v[132:135], v[236:239], v[208:211], v[132:135]
    ds_read_b128 v[160:163], v28 offset:32768
    ds_read_b64_tr_b16 v[176:177], v10 offset:49152
    v_mfma_f32_16x16x32_bf16 v[136:139], v[200:203], v[208:211], v[136:139]
    ds_read_b64_tr_b16 v[178:179], v10 offset:49664
    ds_read_b128 v[164:167], v28 offset:34816
    v_mfma_f32_16x16x32_bf16 v[140:143], v[204:207], v[208:211], v[140:143]
    ds_read_b128 v[168:171], v30 offset:32768
    ds_read_b128 v[172:175], v30 offset:34816
    v_mfma_f32_16x16x32_bf16 v[144:147], v[232:235], v[212:215], v[144:147]
    ds_read_b64_tr_b16 v[180:181], v11 offset:49152
    ds_read_b64_tr_b16 v[182:183], v11 offset:49664
    v_mfma_f32_16x16x32_bf16 v[148:151], v[236:239], v[212:215], v[148:151]
    ds_read_b64_tr_b16 v[184:185], v17 offset:57344
    ds_read_b64_tr_b16 v[186:187], v17 offset:57600
    v_mfma_f32_16x16x32_bf16 v[152:155], v[200:203], v[212:215], v[152:155]
    v_mfma_f32_16x16x32_bf16 v[156:159], v[204:207], v[212:215], v[156:159]
    v_mfma_f32_16x16x32_bf16 v[32:35], v[216:219], v[232:235], v[32:35]
    v_mfma_f32_16x16x32_bf16 v[36:39], v[216:219], v[236:239], v[36:39]
    v_mfma_f32_16x16x32_bf16 v[40:43], v[216:219], v[200:203], v[40:43]
    v_mfma_f32_16x16x32_bf16 v[44:47], v[216:219], v[204:207], v[44:47]
    s_waitcnt lgkmcnt(7)
    v_mfma_f32_16x16x32_bf16 v[128:131], v[160:163], v[176:179], v[128:131]
    ds_read_b128 v[192:195], v29 offset:32768
    ds_read_b64_tr_b16 v[208:209], v10 offset:53248
    s_waitcnt lgkmcnt(8)
    v_mfma_f32_16x16x32_bf16 v[132:135], v[164:167], v[176:179], v[132:135]
    ds_read_b64_tr_b16 v[210:211], v10 offset:53760
    ds_read_b128 v[196:199], v29 offset:34816
    s_waitcnt lgkmcnt(9)
    v_mfma_f32_16x16x32_bf16 v[136:139], v[168:171], v[176:179], v[136:139]
    ds_read_b128 v[200:203], v31 offset:32768
    ds_read_b128 v[204:207], v31 offset:34816
    s_waitcnt lgkmcnt(10)
    v_mfma_f32_16x16x32_bf16 v[140:143], v[172:175], v[176:179], v[140:143]
    ds_read_b64_tr_b16 v[212:213], v11 offset:53248
    ds_read_b64_tr_b16 v[214:215], v11 offset:53760
    s_waitcnt lgkmcnt(10)
    v_mfma_f32_16x16x32_bf16 v[144:147], v[160:163], v[180:183], v[144:147]
    ds_read_b64_tr_b16 v[216:217], v17 offset:59392
    ds_read_b64_tr_b16 v[218:219], v17 offset:59648
    v_mfma_f32_16x16x32_bf16 v[148:151], v[164:167], v[180:183], v[148:151]
    v_mfma_f32_16x16x32_bf16 v[152:155], v[168:171], v[180:183], v[152:155]
    v_mfma_f32_16x16x32_bf16 v[156:159], v[172:175], v[180:183], v[156:159]
    s_waitcnt lgkmcnt(10)
    v_mfma_f32_16x16x32_bf16 v[32:35], v[184:187], v[160:163], v[32:35]
    v_mfma_f32_16x16x32_bf16 v[36:39], v[184:187], v[164:167], v[36:39]
    v_mfma_f32_16x16x32_bf16 v[40:43], v[184:187], v[168:171], v[40:43]
    v_mfma_f32_16x16x32_bf16 v[44:47], v[184:187], v[172:175], v[44:47]
    s_waitcnt lgkmcnt(7)
    v_mfma_f32_16x16x32_bf16 v[128:131], v[192:195], v[208:211], v[128:131]
    s_waitcnt lgkmcnt(0)
    s_barrier
    v_mfma_f32_16x16x32_bf16 v[132:135], v[196:199], v[208:211], v[132:135]
    ds_read_b128 v[160:163], v24 offset:0
    ds_read_b64_tr_b16 v[176:177], v8 offset:16384
    v_mfma_f32_16x16x32_bf16 v[136:139], v[200:203], v[208:211], v[136:139]
    ds_read_b64_tr_b16 v[178:179], v8 offset:16896
    ds_read_b128 v[164:167], v24 offset:2048
    v_mfma_f32_16x16x32_bf16 v[140:143], v[204:207], v[208:211], v[140:143]
    ds_read_b128 v[168:171], v26 offset:0
    ds_read_b128 v[172:175], v26 offset:2048
    v_mfma_f32_16x16x32_bf16 v[144:147], v[192:195], v[212:215], v[144:147]
    ds_read_b64_tr_b16 v[180:181], v9 offset:16384
    ds_read_b64_tr_b16 v[182:183], v9 offset:16896
    v_mfma_f32_16x16x32_bf16 v[148:151], v[196:199], v[212:215], v[148:151]
    ds_read_b64_tr_b16 v[184:185], v16 offset:24576
    ds_read_b64_tr_b16 v[186:187], v16 offset:24832
    v_mfma_f32_16x16x32_bf16 v[152:155], v[200:203], v[212:215], v[152:155]
    v_mfma_f32_16x16x32_bf16 v[156:159], v[204:207], v[212:215], v[156:159]
    v_mfma_f32_16x16x32_bf16 v[32:35], v[216:219], v[192:195], v[32:35]
    v_mfma_f32_16x16x32_bf16 v[36:39], v[216:219], v[196:199], v[36:39]
    v_mfma_f32_16x16x32_bf16 v[40:43], v[216:219], v[200:203], v[40:43]
    v_mfma_f32_16x16x32_bf16 v[44:47], v[216:219], v[204:207], v[44:47]
    s_waitcnt lgkmcnt(7)
    v_mfma_f32_16x16x32_bf16 v[128:131], v[160:163], v[176:179], v[128:131]
    ds_read_b128 v[192:195], v25 offset:0
    ds_read_b64_tr_b16 v[208:209], v8 offset:20480
    s_waitcnt lgkmcnt(8)
    v_mfma_f32_16x16x32_bf16 v[132:135], v[164:167], v[176:179], v[132:135]
    ds_read_b64_tr_b16 v[210:211], v8 offset:20992
    ds_read_b128 v[196:199], v25 offset:2048
    s_waitcnt lgkmcnt(9)
    v_mfma_f32_16x16x32_bf16 v[136:139], v[168:171], v[176:179], v[136:139]
    ds_read_b128 v[200:203], v27 offset:0
    ds_read_b128 v[204:207], v27 offset:2048
    s_waitcnt lgkmcnt(10)
    v_mfma_f32_16x16x32_bf16 v[140:143], v[172:175], v[176:179], v[140:143]
    ds_read_b64_tr_b16 v[212:213], v9 offset:20480
    ds_read_b64_tr_b16 v[214:215], v9 offset:20992
    s_waitcnt lgkmcnt(10)
    v_mfma_f32_16x16x32_bf16 v[144:147], v[160:163], v[180:183], v[144:147]
    ds_read_b64_tr_b16 v[216:217], v16 offset:26624
    ds_read_b64_tr_b16 v[218:219], v16 offset:26880
    v_mfma_f32_16x16x32_bf16 v[148:151], v[164:167], v[180:183], v[148:151]
    v_mfma_f32_16x16x32_bf16 v[152:155], v[168:171], v[180:183], v[152:155]
    v_mfma_f32_16x16x32_bf16 v[156:159], v[172:175], v[180:183], v[156:159]
    s_waitcnt lgkmcnt(10)
    v_mfma_f32_16x16x32_bf16 v[32:35], v[184:187], v[160:163], v[32:35]
    v_mfma_f32_16x16x32_bf16 v[36:39], v[184:187], v[164:167], v[36:39]
    v_mfma_f32_16x16x32_bf16 v[40:43], v[184:187], v[168:171], v[40:43]
    v_mfma_f32_16x16x32_bf16 v[44:47], v[184:187], v[172:175], v[44:47]
    s_waitcnt lgkmcnt(7)
    v_mfma_f32_16x16x32_bf16 v[128:131], v[192:195], v[208:211], v[128:131]
    s_waitcnt vmcnt(0) lgkmcnt(0)
    s_barrier
    v_mfma_f32_16x16x32_bf16 v[132:135], v[196:199], v[208:211], v[132:135]
    ds_read_b128 v[160:163], v24 offset:32768
    ds_read_b64_tr_b16 v[176:177], v8 offset:49152
    v_mfma_f32_16x16x32_bf16 v[136:139], v[200:203], v[208:211], v[136:139]
    ds_read_b64_tr_b16 v[178:179], v8 offset:49664
    ds_read_b128 v[164:167], v24 offset:34816
    v_mfma_f32_16x16x32_bf16 v[140:143], v[204:207], v[208:211], v[140:143]
    ds_read_b128 v[168:171], v26 offset:32768
    ds_read_b128 v[172:175], v26 offset:34816
    v_mfma_f32_16x16x32_bf16 v[144:147], v[192:195], v[212:215], v[144:147]
    ds_read_b64_tr_b16 v[180:181], v9 offset:49152
    ds_read_b64_tr_b16 v[182:183], v9 offset:49664
    v_mfma_f32_16x16x32_bf16 v[148:151], v[196:199], v[212:215], v[148:151]
    ds_read_b64_tr_b16 v[184:185], v16 offset:57344
    ds_read_b64_tr_b16 v[186:187], v16 offset:57600
    v_mfma_f32_16x16x32_bf16 v[152:155], v[200:203], v[212:215], v[152:155]
    v_mfma_f32_16x16x32_bf16 v[156:159], v[204:207], v[212:215], v[156:159]
    v_mfma_f32_16x16x32_bf16 v[32:35], v[216:219], v[192:195], v[32:35]
    v_mfma_f32_16x16x32_bf16 v[36:39], v[216:219], v[196:199], v[36:39]
    v_mfma_f32_16x16x32_bf16 v[40:43], v[216:219], v[200:203], v[40:43]
    v_mfma_f32_16x16x32_bf16 v[44:47], v[216:219], v[204:207], v[44:47]
    s_waitcnt lgkmcnt(7)
    v_mfma_f32_16x16x32_bf16 v[128:131], v[160:163], v[176:179], v[128:131]
    ds_read_b128 v[192:195], v25 offset:32768
    ds_read_b64_tr_b16 v[208:209], v8 offset:53248
    s_waitcnt lgkmcnt(8)
    v_mfma_f32_16x16x32_bf16 v[132:135], v[164:167], v[176:179], v[132:135]
    ds_read_b64_tr_b16 v[210:211], v8 offset:53760
    ds_read_b128 v[196:199], v25 offset:34816
    s_waitcnt lgkmcnt(9)
    v_mfma_f32_16x16x32_bf16 v[136:139], v[168:171], v[176:179], v[136:139]
    ds_read_b128 v[200:203], v27 offset:32768
    ds_read_b128 v[204:207], v27 offset:34816
    s_waitcnt lgkmcnt(10)
    v_mfma_f32_16x16x32_bf16 v[140:143], v[172:175], v[176:179], v[140:143]
    ds_read_b64_tr_b16 v[212:213], v9 offset:53248
    ds_read_b64_tr_b16 v[214:215], v9 offset:53760
    s_waitcnt lgkmcnt(10)
    v_mfma_f32_16x16x32_bf16 v[144:147], v[160:163], v[180:183], v[144:147]
    ds_read_b64_tr_b16 v[216:217], v16 offset:59392
    ds_read_b64_tr_b16 v[218:219], v16 offset:59648
    v_mfma_f32_16x16x32_bf16 v[148:151], v[164:167], v[180:183], v[148:151]
    v_mfma_f32_16x16x32_bf16 v[152:155], v[168:171], v[180:183], v[152:155]
    v_mfma_f32_16x16x32_bf16 v[156:159], v[172:175], v[180:183], v[156:159]
    s_waitcnt lgkmcnt(10)
    v_mfma_f32_16x16x32_bf16 v[32:35], v[184:187], v[160:163], v[32:35]
    v_mfma_f32_16x16x32_bf16 v[36:39], v[184:187], v[164:167], v[36:39]
    v_mfma_f32_16x16x32_bf16 v[40:43], v[184:187], v[168:171], v[40:43]
    v_mfma_f32_16x16x32_bf16 v[44:47], v[184:187], v[172:175], v[44:47]
    s_waitcnt lgkmcnt(7)
    v_mfma_f32_16x16x32_bf16 v[128:131], v[192:195], v[208:211], v[128:131]
    s_waitcnt lgkmcnt(0)
    s_barrier
    v_mfma_f32_16x16x32_bf16 v[132:135], v[196:199], v[208:211], v[132:135]
    ds_read_b128 v[160:163], v28 offset:0
    ds_read_b64_tr_b16 v[176:177], v10 offset:16384
    v_mfma_f32_16x16x32_bf16 v[136:139], v[200:203], v[208:211], v[136:139]
    ds_read_b64_tr_b16 v[178:179], v10 offset:16896
    ds_read_b128 v[164:167], v28 offset:2048
    v_mfma_f32_16x16x32_bf16 v[140:143], v[204:207], v[208:211], v[140:143]
    ds_read_b128 v[168:171], v30 offset:0
    ds_read_b128 v[172:175], v30 offset:2048
    v_mfma_f32_16x16x32_bf16 v[144:147], v[192:195], v[212:215], v[144:147]
    ds_read_b64_tr_b16 v[180:181], v11 offset:16384
    ds_read_b64_tr_b16 v[182:183], v11 offset:16896
    v_mfma_f32_16x16x32_bf16 v[148:151], v[196:199], v[212:215], v[148:151]
    ds_read_b64_tr_b16 v[184:185], v17 offset:24576
    ds_read_b64_tr_b16 v[186:187], v17 offset:24832
    v_mfma_f32_16x16x32_bf16 v[152:155], v[200:203], v[212:215], v[152:155]
    v_mfma_f32_16x16x32_bf16 v[156:159], v[204:207], v[212:215], v[156:159]
    v_mfma_f32_16x16x32_bf16 v[32:35], v[216:219], v[192:195], v[32:35]
    v_mfma_f32_16x16x32_bf16 v[36:39], v[216:219], v[196:199], v[36:39]
    v_mfma_f32_16x16x32_bf16 v[40:43], v[216:219], v[200:203], v[40:43]
    v_mfma_f32_16x16x32_bf16 v[44:47], v[216:219], v[204:207], v[44:47]
    s_waitcnt lgkmcnt(7)
    v_mfma_f32_16x16x32_bf16 v[128:131], v[160:163], v[176:179], v[128:131]
    ds_read_b128 v[192:195], v29 offset:0
    ds_read_b64_tr_b16 v[208:209], v10 offset:20480
    s_waitcnt lgkmcnt(8)
    v_mfma_f32_16x16x32_bf16 v[132:135], v[164:167], v[176:179], v[132:135]
    ds_read_b64_tr_b16 v[210:211], v10 offset:20992
    ds_read_b128 v[196:199], v29 offset:2048
    s_waitcnt lgkmcnt(9)
    v_mfma_f32_16x16x32_bf16 v[136:139], v[168:171], v[176:179], v[136:139]
    ds_read_b128 v[200:203], v31 offset:0
    ds_read_b128 v[204:207], v31 offset:2048
    s_waitcnt lgkmcnt(10)
    v_mfma_f32_16x16x32_bf16 v[140:143], v[172:175], v[176:179], v[140:143]
    ds_read_b64_tr_b16 v[212:213], v11 offset:20480
    ds_read_b64_tr_b16 v[214:215], v11 offset:20992
    s_waitcnt lgkmcnt(10)
    v_mfma_f32_16x16x32_bf16 v[144:147], v[160:163], v[180:183], v[144:147]
    ds_read_b64_tr_b16 v[216:217], v17 offset:26624
    ds_read_b64_tr_b16 v[218:219], v17 offset:26880
    v_mfma_f32_16x16x32_bf16 v[148:151], v[164:167], v[180:183], v[148:151]
    v_mfma_f32_16x16x32_bf16 v[152:155], v[168:171], v[180:183], v[152:155]
    v_mfma_f32_16x16x32_bf16 v[156:159], v[172:175], v[180:183], v[156:159]
    s_waitcnt lgkmcnt(10)
    v_mfma_f32_16x16x32_bf16 v[32:35], v[184:187], v[160:163], v[32:35]
    v_mfma_f32_16x16x32_bf16 v[36:39], v[184:187], v[164:167], v[36:39]
    v_mfma_f32_16x16x32_bf16 v[40:43], v[184:187], v[168:171], v[40:43]
    v_mfma_f32_16x16x32_bf16 v[44:47], v[184:187], v[172:175], v[44:47]
    s_waitcnt lgkmcnt(7)
    v_mfma_f32_16x16x32_bf16 v[128:131], v[192:195], v[208:211], v[128:131]
    s_waitcnt lgkmcnt(0)
    s_barrier
    v_mfma_f32_16x16x32_bf16 v[132:135], v[196:199], v[208:211], v[132:135]
    ds_read_b128 v[160:163], v28 offset:32768
    ds_read_b64_tr_b16 v[176:177], v10 offset:49152
    v_mfma_f32_16x16x32_bf16 v[136:139], v[200:203], v[208:211], v[136:139]
    ds_read_b64_tr_b16 v[178:179], v10 offset:49664
    ds_read_b128 v[164:167], v28 offset:34816
    v_mfma_f32_16x16x32_bf16 v[140:143], v[204:207], v[208:211], v[140:143]
    ds_read_b128 v[168:171], v30 offset:32768
    ds_read_b128 v[172:175], v30 offset:34816
    v_mfma_f32_16x16x32_bf16 v[144:147], v[192:195], v[212:215], v[144:147]
    ds_read_b64_tr_b16 v[180:181], v11 offset:49152
    ds_read_b64_tr_b16 v[182:183], v11 offset:49664
    v_mfma_f32_16x16x32_bf16 v[148:151], v[196:199], v[212:215], v[148:151]
    ds_read_b64_tr_b16 v[184:185], v17 offset:57344
    ds_read_b64_tr_b16 v[186:187], v17 offset:57600
    v_mfma_f32_16x16x32_bf16 v[152:155], v[200:203], v[212:215], v[152:155]
    v_mfma_f32_16x16x32_bf16 v[156:159], v[204:207], v[212:215], v[156:159]
    v_mfma_f32_16x16x32_bf16 v[32:35], v[216:219], v[192:195], v[32:35]
    v_mfma_f32_16x16x32_bf16 v[36:39], v[216:219], v[196:199], v[36:39]
    v_mfma_f32_16x16x32_bf16 v[40:43], v[216:219], v[200:203], v[40:43]
    v_mfma_f32_16x16x32_bf16 v[44:47], v[216:219], v[204:207], v[44:47]
    s_waitcnt lgkmcnt(7)
    v_mfma_f32_16x16x32_bf16 v[128:131], v[160:163], v[176:179], v[128:131]
    ds_read_b128 v[192:195], v29 offset:32768
    ds_read_b64_tr_b16 v[208:209], v10 offset:53248
    s_waitcnt lgkmcnt(8)
    v_mfma_f32_16x16x32_bf16 v[132:135], v[164:167], v[176:179], v[132:135]
    ds_read_b64_tr_b16 v[210:211], v10 offset:53760
    ds_read_b128 v[196:199], v29 offset:34816
    s_waitcnt lgkmcnt(9)
    v_mfma_f32_16x16x32_bf16 v[136:139], v[168:171], v[176:179], v[136:139]
    ds_read_b128 v[200:203], v31 offset:32768
    ds_read_b128 v[204:207], v31 offset:34816
    s_waitcnt lgkmcnt(10)
    v_mfma_f32_16x16x32_bf16 v[140:143], v[172:175], v[176:179], v[140:143]
    ds_read_b64_tr_b16 v[212:213], v11 offset:53248
    ds_read_b64_tr_b16 v[214:215], v11 offset:53760
    s_waitcnt lgkmcnt(10)
    v_mfma_f32_16x16x32_bf16 v[144:147], v[160:163], v[180:183], v[144:147]
    ds_read_b64_tr_b16 v[216:217], v17 offset:59392
    ds_read_b64_tr_b16 v[218:219], v17 offset:59648
    v_mfma_f32_16x16x32_bf16 v[148:151], v[164:167], v[180:183], v[148:151]
    v_mfma_f32_16x16x32_bf16 v[152:155], v[168:171], v[180:183], v[152:155]
    v_mfma_f32_16x16x32_bf16 v[156:159], v[172:175], v[180:183], v[156:159]
    s_waitcnt lgkmcnt(10)
    v_mfma_f32_16x16x32_bf16 v[32:35], v[184:187], v[160:163], v[32:35]
    v_mfma_f32_16x16x32_bf16 v[36:39], v[184:187], v[164:167], v[36:39]
    v_mfma_f32_16x16x32_bf16 v[40:43], v[184:187], v[168:171], v[40:43]
    v_mfma_f32_16x16x32_bf16 v[44:47], v[184:187], v[172:175], v[44:47]
    s_waitcnt lgkmcnt(7)
    v_mfma_f32_16x16x32_bf16 v[128:131], v[192:195], v[208:211], v[128:131]
    s_waitcnt lgkmcnt(0)
    s_barrier
    v_mfma_f32_16x16x32_bf16 v[132:135], v[196:199], v[208:211], v[132:135]
    ds_read_b128 v[48:51], v24 offset:0
    ds_read_b64_tr_b16 v[176:177], v8 offset:16384
    v_mfma_f32_16x16x32_bf16 v[136:139], v[200:203], v[208:211], v[136:139]
    ds_read_b64_tr_b16 v[178:179], v8 offset:16896
    ds_read_b128 v[52:55], v24 offset:2048
    v_mfma_f32_16x16x32_bf16 v[140:143], v[204:207], v[208:211], v[140:143]
    ds_read_b128 v[56:59], v26 offset:0
    ds_read_b128 v[60:63], v26 offset:2048
    v_mfma_f32_16x16x32_bf16 v[144:147], v[192:195], v[212:215], v[144:147]
    ds_read_b64_tr_b16 v[180:181], v9 offset:16384
    ds_read_b64_tr_b16 v[182:183], v9 offset:16896
    v_mfma_f32_16x16x32_bf16 v[148:151], v[196:199], v[212:215], v[148:151]
    v_mfma_f32_16x16x32_bf16 v[152:155], v[200:203], v[212:215], v[152:155]
    v_mfma_f32_16x16x32_bf16 v[156:159], v[204:207], v[212:215], v[156:159]
    v_mfma_f32_16x16x32_bf16 v[32:35], v[216:219], v[192:195], v[32:35]
    v_mfma_f32_16x16x32_bf16 v[36:39], v[216:219], v[196:199], v[36:39]
    v_mfma_f32_16x16x32_bf16 v[40:43], v[216:219], v[200:203], v[40:43]
    v_mfma_f32_16x16x32_bf16 v[44:47], v[216:219], v[204:207], v[44:47]
    s_waitcnt lgkmcnt(5)
    v_mfma_f32_16x16x32_bf16 v[128:131], v[48:51], v[176:179], v[128:131]
    ds_read_b128 v[64:67], v25 offset:0
    ds_read_b64_tr_b16 v[208:209], v8 offset:20480
    s_waitcnt lgkmcnt(6)
    v_mfma_f32_16x16x32_bf16 v[132:135], v[52:55], v[176:179], v[132:135]
    ds_read_b64_tr_b16 v[210:211], v8 offset:20992
    ds_read_b128 v[68:71], v25 offset:2048
    s_waitcnt lgkmcnt(7)
    v_mfma_f32_16x16x32_bf16 v[136:139], v[56:59], v[176:179], v[136:139]
    ds_read_b128 v[72:75], v27 offset:0
    ds_read_b128 v[76:79], v27 offset:2048
    s_waitcnt lgkmcnt(8)
    v_mfma_f32_16x16x32_bf16 v[140:143], v[60:63], v[176:179], v[140:143]
    ds_read_b64_tr_b16 v[212:213], v9 offset:20480
    ds_read_b64_tr_b16 v[214:215], v9 offset:20992
    s_waitcnt lgkmcnt(8)
    v_mfma_f32_16x16x32_bf16 v[144:147], v[48:51], v[180:183], v[144:147]
    v_mfma_f32_16x16x32_bf16 v[148:151], v[52:55], v[180:183], v[148:151]
    v_mfma_f32_16x16x32_bf16 v[152:155], v[56:59], v[180:183], v[152:155]
    v_mfma_f32_16x16x32_bf16 v[156:159], v[60:63], v[180:183], v[156:159]
    s_waitcnt lgkmcnt(5)
    v_mfma_f32_16x16x32_bf16 v[128:131], v[64:67], v[208:211], v[128:131]
    s_waitcnt lgkmcnt(0)
    s_barrier
    v_mfma_f32_16x16x32_bf16 v[132:135], v[68:71], v[208:211], v[132:135]
    ds_read_b128 v[80:83], v24 offset:32768
    ds_read_b64_tr_b16 v[176:177], v8 offset:49152
    v_mfma_f32_16x16x32_bf16 v[136:139], v[72:75], v[208:211], v[136:139]
    ds_read_b64_tr_b16 v[178:179], v8 offset:49664
    ds_read_b128 v[84:87], v24 offset:34816
    v_mfma_f32_16x16x32_bf16 v[140:143], v[76:79], v[208:211], v[140:143]
    ds_read_b128 v[88:91], v26 offset:32768
    ds_read_b128 v[92:95], v26 offset:34816
    v_mfma_f32_16x16x32_bf16 v[144:147], v[64:67], v[212:215], v[144:147]
    ds_read_b64_tr_b16 v[180:181], v9 offset:49152
    ds_read_b64_tr_b16 v[182:183], v9 offset:49664
    v_mfma_f32_16x16x32_bf16 v[148:151], v[68:71], v[212:215], v[148:151]
    ds_read_b128 v[96:99], v25 offset:32768
    ds_read_b64_tr_b16 v[192:193], v8 offset:53248
    v_mfma_f32_16x16x32_bf16 v[152:155], v[72:75], v[212:215], v[152:155]
    ds_read_b64_tr_b16 v[194:195], v8 offset:53760
    ds_read_b128 v[100:103], v25 offset:34816
    v_mfma_f32_16x16x32_bf16 v[156:159], v[76:79], v[212:215], v[156:159]
    ds_read_b128 v[104:107], v27 offset:32768
    ds_read_b128 v[108:111], v27 offset:34816
    s_waitcnt lgkmcnt(11)
    v_mfma_f32_16x16x32_bf16 v[128:131], v[80:83], v[176:179], v[128:131]
    ds_read_b64_tr_b16 v[196:197], v9 offset:53248
    ds_read_b64_tr_b16 v[198:199], v9 offset:53760
    s_waitcnt lgkmcnt(12)
    v_mfma_f32_16x16x32_bf16 v[132:135], v[84:87], v[176:179], v[132:135]
    s_waitcnt lgkmcnt(11)
    v_mfma_f32_16x16x32_bf16 v[136:139], v[88:91], v[176:179], v[136:139]
    s_waitcnt lgkmcnt(10)
    v_mfma_f32_16x16x32_bf16 v[140:143], v[92:95], v[176:179], v[140:143]
    s_waitcnt lgkmcnt(8)
    v_mfma_f32_16x16x32_bf16 v[144:147], v[80:83], v[180:183], v[144:147]
    v_mfma_f32_16x16x32_bf16 v[148:151], v[84:87], v[180:183], v[148:151]
    v_mfma_f32_16x16x32_bf16 v[152:155], v[88:91], v[180:183], v[152:155]
    v_mfma_f32_16x16x32_bf16 v[156:159], v[92:95], v[180:183], v[156:159]
    s_waitcnt lgkmcnt(5)
    v_mfma_f32_16x16x32_bf16 v[128:131], v[96:99], v[192:195], v[128:131]
    s_waitcnt lgkmcnt(0)
    s_barrier
    v_mfma_f32_16x16x32_bf16 v[132:135], v[100:103], v[192:195], v[132:135]
    ds_read_b64_tr_b16 v[112:113], v16 offset:24576
    ds_read_b64_tr_b16 v[114:115], v16 offset:24832
    v_mfma_f32_16x16x32_bf16 v[136:139], v[104:107], v[192:195], v[136:139]
    ds_read_b64_tr_b16 v[116:117], v16 offset:26624
    ds_read_b64_tr_b16 v[118:119], v16 offset:26880
    v_mfma_f32_16x16x32_bf16 v[140:143], v[108:111], v[192:195], v[140:143]
    ds_read_b64_tr_b16 v[120:121], v16 offset:57344
    ds_read_b64_tr_b16 v[122:123], v16 offset:57600
    v_mfma_f32_16x16x32_bf16 v[144:147], v[96:99], v[196:199], v[144:147]
    ds_read_b64_tr_b16 v[124:125], v16 offset:59392
    ds_read_b64_tr_b16 v[126:127], v16 offset:59648
    v_mfma_f32_16x16x32_bf16 v[148:151], v[100:103], v[196:199], v[148:151]
    v_mfma_f32_16x16x32_bf16 v[152:155], v[104:107], v[196:199], v[152:155]
    v_mfma_f32_16x16x32_bf16 v[156:159], v[108:111], v[196:199], v[156:159]
L_fi_2:
    s_waitcnt lgkmcnt(6)
    v_mfma_f32_16x16x32_bf16 v[32:35], v[112:115], v[48:51], v[32:35]
    v_cvt_pk_bf16_f32 v160, v128, v129
    v_cvt_pk_bf16_f32 v161, v130, v131
    v_cvt_pk_bf16_f32 v162, v132, v133
    v_cvt_pk_bf16_f32 v163, v134, v135
    v_mfma_f32_16x16x32_bf16 v[36:39], v[112:115], v[52:55], v[36:39]
    v_permlane16_swap_b32 v160, v162
    v_permlane16_swap_b32 v161, v163
    buffer_store_dwordx4 v[160:163], v18, s[56:59], s83 offen sc1
    v_mfma_f32_16x16x32_bf16 v[40:43], v[112:115], v[56:59], v[40:43]
    v_cvt_pk_bf16_f32 v164, v136, v137
    v_cvt_pk_bf16_f32 v165, v138, v139
    v_cvt_pk_bf16_f32 v166, v140, v141
    v_cvt_pk_bf16_f32 v167, v142, v143
    v_mfma_f32_16x16x32_bf16 v[44:47], v[112:115], v[60:63], v[44:47]
    v_permlane16_swap_b32 v164, v166
    v_permlane16_swap_b32 v165, v167
    buffer_store_dwordx4 v[164:167], v18, s[56:59], s84 offen sc1
    s_waitcnt lgkmcnt(4)
    v_mfma_f32_16x16x32_bf16 v[32:35], v[116:119], v[64:67], v[32:35]
    v_cvt_pk_bf16_f32 v168, v144, v145
    v_cvt_pk_bf16_f32 v169, v146, v147
    v_cvt_pk_bf16_f32 v170, v148, v149
    v_cvt_pk_bf16_f32 v171, v150, v151
    v_mfma_f32_16x16x32_bf16 v[36:39], v[116:119], v[68:71], v[36:39]
    v_permlane16_swap_b32 v168, v170
    v_permlane16_swap_b32 v169, v171
    buffer_store_dwordx4 v[168:171], v18, s[56:59], s85 offen sc1
    v_mfma_f32_16x16x32_bf16 v[40:43], v[116:119], v[72:75], v[40:43]
    v_cvt_pk_bf16_f32 v172, v152, v153
    v_cvt_pk_bf16_f32 v173, v154, v155
    v_cvt_pk_bf16_f32 v174, v156, v157
    v_cvt_pk_bf16_f32 v175, v158, v159
    v_mfma_f32_16x16x32_bf16 v[44:47], v[116:119], v[76:79], v[44:47]
    v_permlane16_swap_b32 v172, v174
    v_permlane16_swap_b32 v173, v175
    buffer_store_dwordx4 v[172:175], v18, s[56:59], s86 offen sc1
    s_waitcnt lgkmcnt(2)
    v_mfma_f32_16x16x32_bf16 v[32:35], v[120:123], v[80:83], v[32:35]
    v_mfma_f32_16x16x32_bf16 v[36:39], v[120:123], v[84:87], v[36:39]
    v_mfma_f32_16x16x32_bf16 v[40:43], v[120:123], v[88:91], v[40:43]
    v_mfma_f32_16x16x32_bf16 v[44:47], v[120:123], v[92:95], v[44:47]
    s_waitcnt lgkmcnt(0)
    v_mfma_f32_16x16x32_bf16 v[32:35], v[124:127], v[96:99], v[32:35]
    v_mfma_f32_16x16x32_bf16 v[36:39], v[124:127], v[100:103], v[36:39]
    v_mfma_f32_16x16x32_bf16 v[40:43], v[124:127], v[104:107], v[40:43]
    v_mfma_f32_16x16x32_bf16 v[44:47], v[124:127], v[108:111], v[44:47]
    s_nop 4
    v_mul_f32 v32, s15, v32
    v_mul_f32 v33, s15, v33
    v_mul_f32 v34, s15, v34
    v_mul_f32 v35, s15, v35
    v_mul_f32 v36, s15, v36
    v_mul_f32 v37, s15, v37
    v_mul_f32 v38, s15, v38
    v_mul_f32 v39, s15, v39
    v_cvt_pk_bf16_f32 v32, v32, v33
    v_cvt_pk_bf16_f32 v33, v34, v35
    v_cvt_pk_bf16_f32 v34, v36, v37
    v_cvt_pk_bf16_f32 v35, v38, v39
    s_nop 0
    v_permlane16_swap_b32 v32, v34
    v_permlane16_swap_b32 v33, v35
    ds_write_b128 v22, v[32:35]
    v_mul_f32 v40, s15, v40
    v_mul_f32 v41, s15, v41
    v_mul_f32 v42, s15, v42
    v_mul_f32 v43, s15, v43
    v_mul_f32 v44, s15, v44
    v_mul_f32 v45, s15, v45
    v_mul_f32 v46, s15, v46
    v_mul_f32 v47, s15, v47
    v_cvt_pk_bf16_f32 v40, v40, v41
    v_cvt_pk_bf16_f32 v41, v42, v43
    v_cvt_pk_bf16_f32 v42, v44, v45
    v_cvt_pk_bf16_f32 v43, v46, v47
    s_nop 0
    v_permlane16_swap_b32 v40, v42
    v_permlane16_swap_b32 v41, v43
    ds_write_b128 v23, v[40:43]
    v_dot2c_f32_bf16 v248, v224, v240
    v_dot2c_f32_bf16 v249, v228, v240
    v_dot2c_f32_bf16 v248, v225, v241
    v_dot2c_f32_bf16 v249, v229, v241
    v_dot2c_f32_bf16 v248, v226, v242
    v_dot2c_f32_bf16 v249, v230, v242
    v_dot2c_f32_bf16 v248, v227, v243
    v_dot2c_f32_bf16 v249, v231, v243
    v_dot2c_f32_bf16 v248, v232, v244
    v_dot2c_f32_bf16 v249, v236, v244
    v_dot2c_f32_bf16 v248, v233, v245
    v_dot2c_f32_bf16 v249, v237, v245
    v_dot2c_f32_bf16 v248, v234, v246
    v_dot2c_f32_bf16 v249, v238, v246
    v_dot2c_f32_bf16 v248, v235, v247
    v_dot2c_f32_bf16 v249, v239, v247
    v_mov_b32 v24, 0
    v_mov_b32 v25, 0
    v_mov_b32 v26, 0
    v_mov_b32 v27, 0
    s_nop 1
    v_mfma_f32_32x32x16_bf16 v[48:63], v[24:27], v[24:27], 0
    v_mfma_f32_32x32x16_bf16 v[64:79], v[24:27], v[24:27], 0
    v_mfma_f32_32x32x16_bf16 v[80:95], v[24:27], v[24:27], 0
    v_mfma_f32_32x32x16_bf16 v[96:111], v[24:27], v[24:27], 0
    s_xor_b32 s8, s4, 1
    v_and_b32 v1, 1, v0
    v_mul_u32_u24 v1, 3, v1
    v_xor_b32 v1, s8, v1
    s_and_b32 s8, s5, 28
    v_and_b32 v17, 3, v0
    v_or_b32 v17, s8, v17
    v_lshl_add_u32 v17, v1, 5, v17
    v_mul_u32_u24 v17, 128, v17
    v_add_u32 v17, 12582912, v17
    v_lshlrev_b32 v13, 4, v0
    v_and_b32 v1, 15, v0
    v_lshrrev_b32 v255, 5, v0
    v_lshl_add_u32 v1, v255, 4, v1
    v_lshlrev_b32 v14, 4, v1
    v_mov_b32 v12, 0xdddddddd
    v_and_b32 v1, 27, v0
    v_cmp_eq_u32 vcc, 16, v1
    v_mov_b32 v1, 0x3f803f80
    s_nop 0
    v_cndmask_b32 v1, 0, v1, vcc
    v_mov_b32 v116, v1
    v_mov_b32 v117, v1
    v_mov_b32 v118, v1
    v_mov_b32 v119, v1
    v_mov_b32 v120, v1
    v_mov_b32 v121, v1
    v_mov_b32 v122, v1
    v_mov_b32 v123, v1
    v_mov_b32 v128, v1
    v_mov_b32 v129, v1
    v_mov_b32 v130, v1
    v_mov_b32 v131, v1
    v_mov_b32 v132, v1
    v_mov_b32 v133, v1
    v_mov_b32 v134, v1
    v_mov_b32 v135, v1
    v_mov_b32 v140, v1
    v_mov_b32 v141, v1
    v_mov_b32 v142, v1
    v_mov_b32 v143, v1
    v_mov_b32 v144, v1
    v_mov_b32 v145, v1
    v_mov_b32 v146, v1
    v_mov_b32 v147, v1
    s_lshr_b32 s9, s5, 2
    s_lshl_b32 s9, s9, 7
    s_add_u32 s9, s9, 11042816
    s_xor_b32 s8, s4, 1
    v_and_b32 v1, 1, v0
    v_mul_u32_u24 v1, 3, v1
    v_xor_b32 v1, s8, v1
    v_and_b32 v19, 3, v0
    v_lshl_add_u32 v19, v1, 2, v19
    v_lshl_add_u32 v19, v19, 2, s9
    s_and_b32 s8, s5, 3
    s_lshl_b32 s10, s4, 2
    s_add_u32 s8, s8, s10
    s_lshl_b32 s8, s8, 2
    s_add_u32 s10, s8, s9
    v_mov_b32 v1, 162820
    v_mov_b32 v2, 1
    s_mov_b64 exec, 1
    s_waitcnt vmcnt(0)
    ds_add_rtn_u32 v2, v1, v2
    s_mov_b64 exec, -1
    s_waitcnt lgkmcnt(0)
    v_readfirstlane_b32 s11, v2
    s_nop 1
    s_cmp_lg_u32 s11, 3
    s_cbranch_scc1 L_nolast_3
    s_mov_b64 exec, 1
    v_mov_b32 v1, s96
    buffer_store_dword v1, off, s[56:59], s10
    s_mov_b64 exec, -1
    s_mov_b64 exec, 1
    v_mov_b32 v1, s96
    buffer_store_dword v1, off, s[56:59], s12 sc1
    s_mov_b64 exec, -1
L_nolast_3:
    s_cmp_lg_u32 s101, 0
    s_cbranch_scc1 L_noz_4
    v_permlane16_swap_b32 v248, v249
    v_add_f32 v248, v248, v249
    v_mov_b32 v2, v248
    s_nop 1
    v_permlane32_swap_b32 v2, v248
    v_add_f32 v2, v2, v248
    buffer_store_dword v2, v20, s[56:59], s13 offen sc1
L_noz_4:
    v_bfe_u32 v1, v0, 4, 1
    v_lshlrev_b32 v1, 2, v1
    v_and_b32 v255, 7, v0
    v_lshlrev_b32 v233, 3, v255
    v_xor_b32 v1, v1, v255
    v_lshlrev_b32 v1, 4, v1
    v_lshrrev_b32 v255, 3, v0
    v_lshl_add_u32 v234, v255, 12, v1
    v_lshl_add_u32 v15, v255, 10, v1
    v_and_b32 v255, 1, v255
    v_lshl_add_u32 v233, v255, 8, v233
    v_lshlrev_b32 v232, 3, v0
    v_lshlrev_b32 v235, 2, v0
    s_and_b32 s8, s5, 1
    s_lshl_b32 s9, s4, 1
    s_add_u32 s8, s8, s9
    s_lshl_b32 s8, s8, 1
    s_add_u32 s8, s8, s80
    s_lshl_b32 s84, s8, 17
    s_add_u32 s84, s84, 2228224
    s_lshl_b32 s72, s80, 12
    s_add_u32 s72, s72, 143872
    s_and_b32 s9, s5, 30
    s_add_u32 s9, s9, s82
    s_lshl_b32 s9, s9, 5
    s_add_u32 s8, s8, s9
    s_lshl_b32 s8, s8, 1
    s_add_u32 s8, s8, s81
    s_lshl_b32 s77, s8, 10
    s_add_u32 s77, s77, 8519680
    s_lshl_b32 s78, s8, 2
    s_add_u32 s78, s78, 10747904
    s_lshr_b32 s8, s5, 2
    s_lshl_b32 s8, s8, 14
    s_lshl_b32 s9, s82, 16
    s_xor_b32 s8, s8, s9
    s_lshl_b32 s9, s81, 11
    s_or_b32 s8, s8, s9
    s_or_b32 s83, s84, s8
    s_lshl_b32 s85, s3, 13
    s_lshl_b32 s8, s4, 7
    s_add_u32 s85, s85, s8
    s_lshl_b32 s86, s3, 10
    s_mov_b32 s88, 0xffff
    s_mov_b32 s89, 0xffff
    s_lshl_b32 s8, s5, 1
    s_add_u32 s8, s8, s80
    s_lshl_b32 s73, s8, 10
    s_add_u32 s73, s73, 11206656
    s_and_b32 s8, s8, 61
    s_lshl_b32 s8, s8, 7
    s_add_u32 s8, s8, 11026432
    v_add_u32 v233, s8, v233
    s_lshl_b32 s74, s4, 18
    s_lshl_b32 s8, s3, 15
    s_add_u32 s74, s74, s8
    s_lshl_b32 s8, s5, 7
    s_add_u32 s74, s74, s8
    s_add_u32 s74, s74, 6422528
    s_lshl_b32 s75, s4, 9
    s_add_u32 s75, s75, 11010048
    v_lshrrev_b32 v156, 5, v0
    v_bfe_u32 v1, v0, 2, 2
    v_lshl_add_u32 v157, v156, 2, v1
    v_lshlrev_b32 v157, 7, v157
    v_lshl_add_u32 v158, v156, 4, v1
    v_lshlrev_b32 v158, 7, v158
    v_and_b32 v159, 30, v0
    v_lshlrev_b32 v159, 10, v159
    v_lshl_add_u32 v159, v156, 5, v159
    v_and_b32 v1, 1, v0
    v_lshl_add_u32 v157, v1, 5, v157
    v_lshl_add_u32 v158, v1, 3, v158
    v_lshl_add_u32 v225, v1, 4, v159
    v_bfe_u32 v1, v0, 4, 1
    v_lshl_add_u32 v157, v1, 4, v157
    v_lshl_add_u32 v158, v1, 5, v158
    v_bfe_u32 v1, v0, 1, 1
    v_lshl_add_u32 v157, v1, 3, v157
    v_lshl_add_u32 v158, v1, 4, v158
    v_bfe_u32 v1, v0, 3, 1
    v_xor_b32 v156, s81, v1
    v_lshl_add_u32 v157, v156, 6, v157
    v_xor_b32 v1, s80, v1
    v_lshl_add_u32 v158, v1, 6, v158
    s_lshl_b32 s8, s81, 15
    v_add_u32 v221, s8, v157
    v_xor_b32 v220, 64, v221
    s_lshl_b32 s8, s81, 12
    s_add_u32 s8, s8, 152064
    v_add_u32 v222, s8, v158
    s_lshl_b32 s8, s3, 12
    s_add_u32 s9, s8, 124928
    s_xor_b32 s8, s8, 8192
    s_add_u32 s8, s8, 124928
    v_add_u32 v223, s9, v13
    v_add_u32 v224, s8, v13
    v_and_b32 v1, 15, v0
    v_lshlrev_b32 v226, 3, v1
    s_lshl_b32 s8, s5, 8
    s_lshl_b32 s9, s81, 7
    s_add_u32 s8, s8, s9
    s_lshl_b32 s9, s80, 2
    s_add_u32 s8, s8, s9
    s_lshl_b32 s87, s8, 8
    s_add_u32 s87, s87, 8519680
    s_lshl_b32 s76, s8, 0
    s_add_u32 s76, s76, 10747904
    s_lshl_b32 s100, s5, 16
    s_lshl_b32 s8, s80, 15
    s_add_u32 s100, s100, s8
    s_lshl_b32 s8, s4, 7
    s_add_u32 s100, s100, s8
    s_lshl_b32 s8, s81, 6
    s_add_u32 s100, s100, s8
    s_cmp_lg_u32 s11, 3
    s_cbranch_scc1 L_nopoll_5
    s_mov_b32 s8, 8
L_pl_7:
    buffer_load_dword v18, v19, s[56:59], 0 offen sc1
L_ple_9:
    s_waitcnt vmcnt(0)
    v_cmp_ne_u32 vcc, s96, v18
    s_nop 1
    s_cbranch_vccz L_pld_8
    s_mov_b64 exec, vcc
    s_sub_u32 s8, s8, 1
    s_cmp_lg_u32 s8, 0
    s_cbranch_scc1 L_pl_7
L_pld_8:
    s_mov_b64 exec, -1
    s_cbranch_vccz L_near_6
    s_mov_b32 s8, 400000
L_pl_10:
    buffer_load_dword v18, v17, s[56:59], 0 offen sc1
L_ple_12:
    s_waitcnt vmcnt(0)
    v_cmp_ne_u32 vcc, s96, v18
    s_nop 1
    s_cbranch_vccz L_pld_11
    s_mov_b64 exec, vcc
    s_sub_u32 s8, s8, 1
    s_cmp_lg_u32 s8, 0
    s_cbranch_scc1 L_pl_10
L_pld_11:
    s_mov_b64 exec, -1
L_near_6:
    s_mov_b64 exec, 1
    v_mov_b32 v1, 162848
    v_mov_b32 v2, 1
    ds_add_u32 v1, v2
    s_mov_b64 exec, -1
L_nopoll_5:
    s_waitcnt vmcnt(0)
    v_mov_b32 v244, 162848
    s_mov_b32 s8, 3200000
L_lw_13:
    ds_read_b32 v245, v244
    s_waitcnt lgkmcnt(0)
    v_readfirstlane_b32 s9, v245
    s_nop 1
    s_cmp_ge_u32 s9, 1
    s_cbranch_scc1 L_lwd_14
    s_sleep 1
    s_sub_u32 s8, s8, 1
    s_cmp_lg_u32 s8, 0
    s_cbranch_scc1 L_lw_13
L_lwd_14:
    buffer_load_dwordx4 v[112:115], v13, s[56:59], s83 offen sc1
    s_mov_b64 exec, s[88:89]
    buffer_load_dwordx4 v[116:119], v14, s[56:59], s83 offen offset:1024 sc1
    buffer_load_dwordx4 v[120:123], v14, s[56:59], s83 offen offset:1536 sc1
    s_mov_b64 exec, -1
    s_add_u32 s83, s83, 4096
    buffer_load_dwordx4 v[124:127], v13, s[56:59], s83 offen sc1
    s_mov_b64 exec, s[88:89]
    buffer_load_dwordx4 v[128:131], v14, s[56:59], s83 offen offset:1024 sc1
    buffer_load_dwordx4 v[132:135], v14, s[56:59], s83 offen offset:1536 sc1
    s_mov_b64 exec, -1
    s_add_u32 s83, s83, 4096
    buffer_load_dwordx4 v[136:139], v13, s[56:59], s83 offen sc1
    s_mov_b64 exec, s[88:89]
    buffer_load_dwordx4 v[140:143], v14, s[56:59], s83 offen offset:1024 sc1
    buffer_load_dwordx4 v[144:147], v14, s[56:59], s83 offen offset:1536 sc1
    s_mov_b64 exec, -1
    s_add_u32 s83, s83, 4096
    s_lshr_b32 s9, s3, 1
    s_add_u32 s8, s9, 1
    s_and_b32 s8, s8, 3
    s_lshl_b32 s8, s8, 10
    s_add_u32 s8, s8, s72
    v_add_u32 v255, s8, v13
    ds_read_b128 v[4:7], v255
    s_add_u32 s8, s9, 2
    s_and_b32 s8, s8, 3
    s_lshl_b32 s8, s8, 10
    s_add_u32 s8, s8, s72
    v_add_u32 v255, s8, v13
    ds_read_b128 v[8:11], v255
    s_add_u32 s8, s9, 3
    s_and_b32 s8, s8, 3
    s_lshl_b32 s8, s8, 10
    s_add_u32 s8, s8, s72
    v_add_u32 v255, s8, v13
    ds_read_b128 v[148:151], v255
    s_add_u32 s8, s9, 4
    s_and_b32 s8, s8, 3
    s_lshl_b32 s8, s8, 10
    s_add_u32 s8, s8, s72
    v_add_u32 v255, s8, v13
    ds_read_b128 v[152:155], v255
    v_lshrrev_b32 v2, 5, v0
    v_mul_u32_u24 v2, 384, v2
    v_add_u32 v2, v2, v235
    s_cmp_lg_u32 s101, 0
    s_cbranch_scc1 L_attn
    s_mov_b64 exec, 1
    v_mov_b32 v22, s96
    v_mov_b32 v23, s97
    buffer_store_dwordx2 v[22:23], off, s[56:59], s14 sc1
    s_mov_b64 exec, -1
    s_branch L_attn
L_ssm:
    s_add_u32 s94, s46, 11018240
    s_addc_u32 s95, s47, 0
    s_load_dword s96, s[94:95], 0
    s_getreg_b32 s97, hwreg(HW_REG_XCC_ID, 0, 4)
    s_lshl_b32 s100, s7, 1
    s_add_u32 s100, s100, s81
    s_mov_b32 s56, s46
    s_and_b32 s57, s47, 0xffff
    s_mov_b32 s58, 0xf00000
    s_mov_b32 s59, 0x20000
    s_mov_b32 s60, s38
    s_and_b32 s61, s39, 0xffff
    s_mov_b32 s62, 0x80000
    s_mov_b32 s63, 0x20000
    s_mov_b32 s64, s42
    s_and_b32 s65, s43, 0xffff
    s_mov_b32 s66, 0x200000
    s_mov_b32 s67, 0x20000
    v_mov_b32 v28, 0
    v_mov_b32 v29, 0
    v_mov_b32 v30, 0
    v_mov_b32 v31, 0
    v_and_b32 v1, 3, v0
    v_lshlrev_b32 v1, 4, v1
    v_add_u32 v1, 162816, v1
    ds_write_b128 v1, v[28:31]
    v_and_b32 v1, 31, v0
    v_lshlrev_b32 v1, 4, v1
    v_lshrrev_b32 v15, 5, v0
    v_mul_u32_u24 v12, 4608, v15
    v_add_u32 v1, v1, v12
    v_add_u32 v1, 131584, v1
    ds_write_b128 v1, v[28:31]
    s_mul_i32 s86, s81, 16640
    s_add_u32 s86, s86, 98304
    s_lshl_b32 s8, s79, 13
    s_add_u32 s84, s8, 65536
    s_mul_i32 s85, s81, 4608
    s_add_u32 s85, s85, 131584
    v_and_b32 v1, 7, v0
    v_min_u32 v1, 6, v1
    v_lshlrev_b32 v1, 3, v1
    v_bfe_u32 v12, v0, 3, 1
    v_mul_u32_u24 v12, 4160, v12
    s_mul_i32 s8, s80, 8320
    s_add_u32 s8, s8, s86
    v_add3_u32 v19, v1, v12, s8
    v_and_b32 v1, 1, v0
    v_lshlrev_b32 v1, 4, v1
    v_mov_b32 v16, 0x3f80
    v_lshlrev_b32 v16, v1, v16
    v_bfe_u32 v1, v0, 1, 4
    v_lshlrev_b32 v17, 2, v15
    v_sub_u32 v1, v1, v17
    v_cmp_eq_u32 vcc, 0, v1
    v_cmp_eq_u32 s[8:9], 1, v1
    s_nop 0
    v_cndmask_b32 v220, 0, v16, vcc
    v_cndmask_b32 v221, 0, v16, s[8:9]
    v_cmp_eq_u32 vcc, 2, v1
    v_cmp_eq_u32 s[8:9], 3, v1
    s_nop 0
    v_cndmask_b32 v222, 0, v16, vcc
    v_cndmask_b32 v223, 0, v16, s[8:9]
    v_cmp_eq_u32 vcc, 8, v1
    v_cmp_eq_u32 s[8:9], 9, v1
    s_nop 0
    v_cndmask_b32 v224, 0, v16, vcc
    v_cndmask_b32 v225, 0, v16, s[8:9]
    v_cmp_eq_u32 vcc, 10, v1
    v_cmp_eq_u32 s[8:9], 11, v1
    s_nop 0
    v_cndmask_b32 v226, 0, v16, vcc
    v_cndmask_b32 v227, 0, v16, s[8:9]
    v_lshrrev_b32 v18, 4, v0
    v_bfe_u32 v16, v0, 2, 2
    v_lshl_add_u32 v1, v18, 4, v16
    v_lshlrev_b32 v1, 7, v1
    v_bfe_u32 v16, v0, 1, 1
    v_bfe_u32 v17, v0, 3, 1
    v_xor_b32 v16, v16, v17
    s_lshl_b32 s8, s79, 1
    v_or_b32 v16, s8, v16
    v_lshl_add_u32 v1, v16, 4, v1
    s_lshl_b32 s8, s71, 13
    s_add_u32 s8, s8, 65536
    v_add_u32 v1, s8, v1
    v_and_b32 v16, 1, v0
    v_lshl_add_u32 v8, v16, 3, v1
    v_xor_b32 v9, 32, v8
    v_xor_b32 v10, 64, v8
    v_xor_b32 v11, 96, v8
    v_and_b32 v1, 14, v0
    v_mul_u32_u24 v1, 4224, v1
    v_lshl_add_u32 v1, v18, 5, v1
    v_lshl_add_u32 v12, v16, 4, v1
    s_lshl_b32 s8, s6, 2
    s_add_u32 s8, s8, s79
    s_mul_i32 s14, s8, 67584
    s_lshl_b32 s9, s5, 7
    s_add_u32 s14, s14, s9
    s_add_u32 s15, s14, 4224
    s_lshl_b32 s8, s8, 5
    s_add_u32 s8, s8, s5
    s_lshl_b32 s8, s8, 2
    s_add_u32 s87, s8, 11075584
    s_lshl_b32 s91, s7, 4
    s_lshl_b32 s9, s79, 2
    s_add_u32 s91, s91, s9
    s_add_u32 s91, s91, 11010048
    s_lshl_b32 s8, s79, 11
    s_xor_b32 s9, s8, 2048
    s_add_u32 s8, s8, 152064
    s_add_u32 s9, s9, 152064
    v_lshl_add_u32 v249, v0, 4, s8
    v_lshl_add_u32 v250, v0, 4, s9
    v_lshl_add_u32 v251, v0, 4, s85
    s_mov_b32 s10, 0xaaaaaaaa
    s_mov_b32 s11, 0xaaaaaaaa
    v_mov_b32 v48, 1.0
    v_mov_b32 v49, 0
    s_waitcnt vmcnt(5)
    v_lshlrev_b32 v26, 16, v26
    v_lshlrev_b32 v20, 16, v20
    v_lshlrev_b32 v21, 16, v21
    s_mov_b32 s8, 0x3fb8aa3b
    v_mul_f32 v16, s8, v26
    v_fma_f32 v17, v26, s8, -v16
    v_fmac_f32 v17, 0x32a57060, v26
    v_exp_f32 v16, v16
    v_mul_f32 v17, 0x3f317218, v17
    v_fmac_f32 v16, v16, v17
    v_cvt_pk_bf16_f32 v16, v16, v16
    v_lshlrev_b32 v26, 16, v16
    v_mul_f32 v20, v26, v20
    v_mul_f32 v21, v26, v21
    v_mul_f32 v20, s8, v20
    v_mul_f32 v21, 0.15915494, v21
    v_mul_f32 v16, 0x41000000, v20
    v_mul_f32 v17, 0x41000000, v21
    v_exp_f32 v16, v16
    v_fract_f32 v17, v17
    v_cos_f32 v50, v17
    v_sin_f32 v51, v17
    v_mul_f32 v50, v16, v50
    v_mul_f32 v51, v16, v51
    v_pk_mul_f32 v[52:53], v[50:51], v[50:51] op_sel:[0,0] op_sel_hi:[1,0]
    v_pk_fma_f32 v[52:53], v[50:51], v[50:51], v[52:53] op_sel:[1,1,0] op_sel_hi:[0,1,1] neg_lo:[0,1,0]
    v_pk_mul_f32 v[54:55], v[52:53], v[50:51] op_sel:[0,0] op_sel_hi:[1,0]
    v_pk_fma_f32 v[54:55], v[52:53], v[50:51], v[54:55] op_sel:[1,1,0] op_sel_hi:[0,1,1] neg_lo:[0,1,0]
    v_pk_mul_f32 v[56:57], v[54:55], v[50:51] op_sel:[0,0] op_sel_hi:[1,0]
    v_pk_fma_f32 v[56:57], v[54:55], v[50:51], v[56:57] op_sel:[1,1,0] op_sel_hi:[0,1,1] neg_lo:[0,1,0]
    v_pk_mul_f32 v[58:59], v[56:57], v[50:51] op_sel:[0,0] op_sel_hi:[1,0]
    v_pk_fma_f32 v[58:59], v[56:57], v[50:51], v[58:59] op_sel:[1,1,0] op_sel_hi:[0,1,1] neg_lo:[0,1,0]
    v_pk_mul_f32 v[60:61], v[58:59], v[50:51] op_sel:[0,0] op_sel_hi:[1,0]
    v_pk_fma_f32 v[60:61], v[58:59], v[50:51], v[60:61] op_sel:[1,1,0] op_sel_hi:[0,1,1] neg_lo:[0,1,0]
    v_pk_mul_f32 v[62:63], v[60:61], v[50:51] op_sel:[0,0] op_sel_hi:[1,0]
    v_pk_fma_f32 v[62:63], v[60:61], v[50:51], v[62:63] op_sel:[1,1,0] op_sel_hi:[0,1,1] neg_lo:[0,1,0]
    v_cvt_pk_bf16_f32 v156, v48, v50
    v_cvt_pk_bf16_f32 v157, v52, v54
    v_cvt_pk_bf16_f32 v158, v56, v58
    v_cvt_pk_bf16_f32 v159, v60, v62
    v_pk_mul_f32 v[64:65], v[62:63], v[50:51] op_sel:[0,0] op_sel_hi:[1,0]
    v_pk_fma_f32 v[64:65], v[62:63], v[50:51], v[64:65] op_sel:[1,1,0] op_sel_hi:[0,1,1] neg_lo:[0,1,0]
    v_pk_mul_f32 v[66:67], v[64:65], v[50:51] op_sel:[0,0] op_sel_hi:[1,0]
    v_pk_fma_f32 v[66:67], v[64:65], v[50:51], v[66:67] op_sel:[1,1,0] op_sel_hi:[0,1,1] neg_lo:[0,1,0]
    v_pk_mul_f32 v[68:69], v[66:67], v[50:51] op_sel:[0,0] op_sel_hi:[1,0]
    v_pk_fma_f32 v[68:69], v[66:67], v[50:51], v[68:69] op_sel:[1,1,0] op_sel_hi:[0,1,1] neg_lo:[0,1,0]
    v_pk_mul_f32 v[70:71], v[68:69], v[50:51] op_sel:[0,0] op_sel_hi:[1,0]
    v_pk_fma_f32 v[70:71], v[68:69], v[50:51], v[70:71] op_sel:[1,1,0] op_sel_hi:[0,1,1] neg_lo:[0,1,0]
    v_cvt_pk_bf16_f32 v172, v49, v51
    v_cvt_pk_bf16_f32 v173, v53, v55
    v_cvt_pk_bf16_f32 v174, v57, v59
    v_cvt_pk_bf16_f32 v175, v61, v63
    v_pk_mul_f32 v[72:73], v[70:71], v[50:51] op_sel:[0,0] op_sel_hi:[1,0]
    v_pk_fma_f32 v[72:73], v[70:71], v[50:51], v[72:73] op_sel:[1,1,0] op_sel_hi:[0,1,1] neg_lo:[0,1,0]
    v_pk_mul_f32 v[74:75], v[72:73], v[50:51] op_sel:[0,0] op_sel_hi:[1,0]
    v_pk_fma_f32 v[74:75], v[72:73], v[50:51], v[74:75] op_sel:[1,1,0] op_sel_hi:[0,1,1] neg_lo:[0,1,0]
    v_pk_mul_f32 v[76:77], v[74:75], v[50:51] op_sel:[0,0] op_sel_hi:[1,0]
    v_pk_fma_f32 v[76:77], v[74:75], v[50:51], v[76:77] op_sel:[1,1,0] op_sel_hi:[0,1,1] neg_lo:[0,1,0]
    v_pk_mul_f32 v[78:79], v[76:77], v[50:51] op_sel:[0,0] op_sel_hi:[1,0]
    v_pk_fma_f32 v[78:79], v[76:77], v[50:51], v[78:79] op_sel:[1,1,0] op_sel_hi:[0,1,1] neg_lo:[0,1,0]
    v_cvt_pk_bf16_f32 v160, v64, v66
    v_cvt_pk_bf16_f32 v161, v68, v70
    v_cvt_pk_bf16_f32 v162, v72, v74
    v_cvt_pk_bf16_f32 v163, v76, v78
    v_pk_mul_f32 v[80:81], v[78:79], v[50:51] op_sel:[0,0] op_sel_hi:[1,0]
    v_pk_fma_f32 v[80:81], v[78:79], v[50:51], v[80:81] op_sel:[1,1,0] op_sel_hi:[0,1,1] neg_lo:[0,1,0]
    v_pk_mul_f32 v[82:83], v[80:81], v[50:51] op_sel:[0,0] op_sel_hi:[1,0]
    v_pk_fma_f32 v[82:83], v[80:81], v[50:51], v[82:83] op_sel:[1,1,0] op_sel_hi:[0,1,1] neg_lo:[0,1,0]
    v_pk_mul_f32 v[84:85], v[82:83], v[50:51] op_sel:[0,0] op_sel_hi:[1,0]
    v_pk_fma_f32 v[84:85], v[82:83], v[50:51], v[84:85] op_sel:[1,1,0] op_sel_hi:[0,1,1] neg_lo:[0,1,0]
    v_pk_mul_f32 v[86:87], v[84:85], v[50:51] op_sel:[0,0] op_sel_hi:[1,0]
    v_pk_fma_f32 v[86:87], v[84:85], v[50:51], v[86:87] op_sel:[1,1,0] op_sel_hi:[0,1,1] neg_lo:[0,1,0]
    v_cvt_pk_bf16_f32 v176, v65, v67
    v_cvt_pk_bf16_f32 v177, v69, v71
    v_cvt_pk_bf16_f32 v178, v73, v75
    v_cvt_pk_bf16_f32 v179, v77, v79
    v_pk_mul_f32 v[88:89], v[86:87], v[50:51] op_sel:[0,0] op_sel_hi:[1,0]
    v_pk_fma_f32 v[88:89], v[86:87], v[50:51], v[88:89] op_sel:[1,1,0] op_sel_hi:[0,1,1] neg_lo:[0,1,0]
    v_pk_mul_f32 v[90:91], v[88:89], v[50:51] op_sel:[0,0] op_sel_hi:[1,0]
    v_pk_fma_f32 v[90:91], v[88:89], v[50:51], v[90:91] op_sel:[1,1,0] op_sel_hi:[0,1,1] neg_lo:[0,1,0]
    v_pk_mul_f32 v[92:93], v[90:91], v[50:51] op_sel:[0,0] op_sel_hi:[1,0]
    v_pk_fma_f32 v[92:93], v[90:91], v[50:51], v[92:93] op_sel:[1,1,0] op_sel_hi:[0,1,1] neg_lo:[0,1,0]
    v_pk_mul_f32 v[94:95], v[92:93], v[50:51] op_sel:[0,0] op_sel_hi:[1,0]
    v_pk_fma_f32 v[94:95], v[92:93], v[50:51], v[94:95] op_sel:[1,1,0] op_sel_hi:[0,1,1] neg_lo:[0,1,0]
    v_cvt_pk_bf16_f32 v164, v80, v82
    v_cvt_pk_bf16_f32 v165, v84, v86
    v_cvt_pk_bf16_f32 v166, v88, v90
    v_cvt_pk_bf16_f32 v167, v92, v94
    v_pk_mul_f32 v[96:97], v[94:95], v[50:51] op_sel:[0,0] op_sel_hi:[1,0]
    v_pk_fma_f32 v[96:97], v[94:95], v[50:51], v[96:97] op_sel:[1,1,0] op_sel_hi:[0,1,1] neg_lo:[0,1,0]
    v_pk_mul_f32 v[98:99], v[96:97], v[50:51] op_sel:[0,0] op_sel_hi:[1,0]
    v_pk_fma_f32 v[98:99], v[96:97], v[50:51], v[98:99] op_sel:[1,1,0] op_sel_hi:[0,1,1] neg_lo:[0,1,0]
    v_pk_mul_f32 v[100:101], v[98:99], v[50:51] op_sel:[0,0] op_sel_hi:[1,0]
    v_pk_fma_f32 v[100:101], v[98:99], v[50:51], v[100:101] op_sel:[1,1,0] op_sel_hi:[0,1,1] neg_lo:[0,1,0]
    v_pk_mul_f32 v[102:103], v[100:101], v[50:51] op_sel:[0,0] op_sel_hi:[1,0]
    v_pk_fma_f32 v[102:103], v[100:101], v[50:51], v[102:103] op_sel:[1,1,0] op_sel_hi:[0,1,1] neg_lo:[0,1,0]
    v_cvt_pk_bf16_f32 v180, v81, v83
    v_cvt_pk_bf16_f32 v181, v85, v87
    v_cvt_pk_bf16_f32 v182, v89, v91
    v_cvt_pk_bf16_f32 v183, v93, v95
    v_pk_mul_f32 v[104:105], v[102:103], v[50:51] op_sel:[0,0] op_sel_hi:[1,0]
    v_pk_fma_f32 v[104:105], v[102:103], v[50:51], v[104:105] op_sel:[1,1,0] op_sel_hi:[0,1,1] neg_lo:[0,1,0]
    v_pk_mul_f32 v[106:107], v[104:105], v[50:51] op_sel:[0,0] op_sel_hi:[1,0]
    v_pk_fma_f32 v[106:107], v[104:105], v[50:51], v[106:107] op_sel:[1,1,0] op_sel_hi:[0,1,1] neg_lo:[0,1,0]
    v_pk_mul_f32 v[108:109], v[106:107], v[50:51] op_sel:[0,0] op_sel_hi:[1,0]
    v_pk_fma_f32 v[108:109], v[106:107], v[50:51], v[108:109] op_sel:[1,1,0] op_sel_hi:[0,1,1] neg_lo:[0,1,0]
    v_pk_mul_f32 v[110:111], v[108:109], v[50:51] op_sel:[0,0] op_sel_hi:[1,0]
    v_pk_fma_f32 v[110:111], v[108:109], v[50:51], v[110:111] op_sel:[1,1,0] op_sel_hi:[0,1,1] neg_lo:[0,1,0]
    v_cvt_pk_bf16_f32 v168, v96, v98
    v_cvt_pk_bf16_f32 v169, v100, v102
    v_cvt_pk_bf16_f32 v170, v104, v106
    v_cvt_pk_bf16_f32 v171, v108, v110
    v_exp_f32 v16, v20
    v_fract_f32 v17, v21
    v_cos_f32 v32, v17
    v_sin_f32 v33, v17
    v_mul_f32 v32, v16, v32
    v_mul_f32 v33, v16, v33
    v_cvt_pk_bf16_f32 v184, v97, v99
    v_cvt_pk_bf16_f32 v185, v101, v103
    v_cvt_pk_bf16_f32 v186, v105, v107
    v_cvt_pk_bf16_f32 v187, v109, v111
    v_mul_f32 v16, 0x43800000, v20
    v_mul_f32 v17, 0x43800000, v21
    v_exp_f32 v16, v16
    v_fract_f32 v17, v17
    v_cos_f32 v34, v17
    v_sin_f32 v35, v17
    v_mul_f32 v34, v16, v34
    v_mul_f32 v35, v16, v35
    v_pk_mul_f32 v[36:37], v[32:33], v[32:33] op_sel:[0,0] op_sel_hi:[1,0]
    v_pk_fma_f32 v[36:37], v[32:33], v[32:33], v[36:37] op_sel:[1,1,0] op_sel_hi:[0,1,1] neg_lo:[0,1,0]
    v_pk_mul_f32 v[38:39], v[36:37], v[36:37] op_sel:[0,0] op_sel_hi:[1,0]
    v_pk_fma_f32 v[38:39], v[36:37], v[36:37], v[38:39] op_sel:[1,1,0] op_sel_hi:[0,1,1] neg_lo:[0,1,0]
    v_mov_b32 v40, v50
    v_mov_b32 v41, v51
    s_waitcnt lgkmcnt(0)
    s_mul_i32 s96, s96, 0x9e3779b1
    s_add_u32 s96, s96, 0x7f4a7c15
    s_setprio 3
    s_add_u32 m0, s72, 16384
    s_add_u32 s78, s6, 2
    s_and_b32 s78, s78, 7
    s_mul_i32 s76, s78, 196608
    s_add_u32 s77, s76, s70
    buffer_load_dwordx4 v6, s[52:55], s77 offen offset:0 lds
    buffer_load_dwordx4 v7, s[52:55], s77 offen offset:1024 lds
    s_barrier
    ds_read_b64_tr_b16 v[236:237], v8 offset:0
    ds_read_b64_tr_b16 v[238:239], v9 offset:512
    ds_read_b64_tr_b16 v[240:241], v10 offset:1024
    ds_read_b64_tr_b16 v[242:243], v11 offset:1536
    s_waitcnt vmcnt(2)
    v_lshlrev_b32 v27, 16, v27
    s_add_u32 m0, s69, 24576
    s_add_u32 s76, s76, s74
    buffer_load_dwordx4 v136, s[52:55], s76 offen offset:0 lds
    v_permlane32_swap_b32 v156, v160
    v_permlane32_swap_b32 v157, v161
    v_permlane32_swap_b32 v158, v162
    v_permlane32_swap_b32 v159, v163
    v_permlane32_swap_b32 v164, v168
    v_permlane32_swap_b32 v165, v169
    v_permlane32_swap_b32 v166, v170
    v_permlane32_swap_b32 v167, v171
    v_permlane32_swap_b32 v172, v176
    v_permlane32_swap_b32 v173, v177
    v_permlane32_swap_b32 v174, v178
    v_permlane32_swap_b32 v175, v179
    s_add_u32 m0, s68, 0
    s_lshl_b32 s75, s78, 7
    s_add_u32 s75, s75, s73
    buffer_load_dwordx4 v4, s[48:51], s75 offen offset:0 lds
    v_permlane32_swap_b32 v180, v184
    v_permlane32_swap_b32 v181, v185
    v_permlane32_swap_b32 v182, v186
    v_permlane32_swap_b32 v183, v187
    v_mfma_f32_32x32x16_bf16 v[104:119], v[156:159], v[220:223], 0
    v_lshlrev_b32 v22, 16, v22
    v_lshlrev_b32 v23, 16, v23
    v_lshlrev_b32 v24, 16, v24
    v_lshlrev_b32 v25, 16, v25
    v_mul_f32 v22, v26, v22
    v_mul_f32 v23, v26, v23
    v_mfma_f32_32x32x16_bf16 v[104:119], v[164:167], v[224:227], v[104:119]
    buffer_load_dwordx4 v5, s[48:51], s75 offen offset:1024 lds
    v_mul_f32 v48, v24, v22
    v_mul_f32 v49, v25, v22
    v_fma_f32 v48, -v25, v23, v48
    v_fmac_f32 v49, v24, v23
    v_mul_f32 v50, v48, v32
    v_mul_f32 v51, v49, v32
    v_mfma_f32_32x32x16_bf16 v[120:135], v[172:175], v[220:223], 0
    v_fma_f32 v50, -v49, v33, v50
    v_fmac_f32 v51, v48, v33
    v_mul_f32 v52, v50, v32
    v_mul_f32 v53, v51, v32
    v_fma_f32 v52, -v51, v33, v52
    s_add_u32 s75, s75, 14336
    buffer_load_dwordx4 v4, s[48:51], s75 offen offset:2048 lds
    v_fmac_f32 v53, v50, v33
    v_mfma_f32_32x32x16_bf16 v[120:135], v[180:183], v[224:227], v[120:135]
    v_mul_f32 v54, v52, v32
    v_mul_f32 v55, v53, v32
    v_fma_f32 v54, -v53, v33, v54
    v_fmac_f32 v55, v52, v33
    v_mul_f32 v64, v48, v34
    v_mul_f32 v65, v49, v34
    v_fma_f32 v64, -v49, v35, v64
    v_fmac_f32 v65, v48, v35
    v_mul_f32 v66, v64, v36
    v_mul_f32 v67, v65, v36
    s_not_b64 vcc, s[10:11]
    s_waitcnt lgkmcnt(0)
    v_cndmask_b32_dpp v148, v240, v236, vcc quad_perm:[1,0,3,2] row_mask:0xf bank_mask:0xf
    v_cndmask_b32_dpp v149, v241, v237, vcc quad_perm:[1,0,3,2] row_mask:0xf bank_mask:0xf
    v_cndmask_b32_dpp v150, v242, v238, vcc quad_perm:[1,0,3,2] row_mask:0xf bank_mask:0xf
    v_cndmask_b32_dpp v151, v243, v239, vcc quad_perm:[1,0,3,2] row_mask:0xf bank_mask:0xf
    s_mov_b64 vcc, s[10:11]
    v_cndmask_b32_dpp v152, v236, v240, vcc quad_perm:[1,0,3,2] row_mask:0xf bank_mask:0xf
    v_cndmask_b32_dpp v153, v237, v241, vcc quad_perm:[1,0,3,2] row_mask:0xf bank_mask:0xf
    v_cndmask_b32_dpp v154, v238, v242, vcc quad_perm:[1,0,3,2] row_mask:0xf bank_mask:0xf
    v_cndmask_b32_dpp v155, v239, v243, vcc quad_perm:[1,0,3,2] row_mask:0xf bank_mask:0xf
    buffer_store_dwordx4 v[148:151], v12, s[56:59], s14 offen sc1
    buffer_store_dwordx4 v[152:155], v12, s[56:59], s15 offen sc1
    buffer_load_dwordx4 v5, s[48:51], s75 offen offset:3072 lds
    v_fma_f32 v66, -v65, v37, v66
    v_fmac_f32 v67, v64, v37
    v_cvt_pk_bf16_f32 v156, v104, v120
    v_cvt_pk_bf16_f32 v157, v105, v121
    v_cvt_pk_bf16_f32 v158, v106, v122
    v_cvt_pk_bf16_f32 v159, v107, v123
    v_cvt_pk_bf16_f32 v164, v108, v124
    v_cvt_pk_bf16_f32 v165, v109, v125
    v_cvt_pk_bf16_f32 v166, v110, v126
    v_cvt_pk_bf16_f32 v167, v111, v127
    v_cvt_pk_bf16_f32 v172, v112, v128
    v_cvt_pk_bf16_f32 v173, v113, v129
    s_add_u32 m0, s72, 49152
    s_add_u32 s78, s6, 3
    s_and_b32 s78, s78, 7
    s_mul_i32 s76, s78, 196608
    s_add_u32 s77, s76, s70
    buffer_load_dwordx4 v6, s[52:55], s77 offen offset:0 lds
    v_cvt_pk_bf16_f32 v174, v114, v130
    v_cvt_pk_bf16_f32 v175, v115, v131
    v_cvt_pk_bf16_f32 v180, v116, v132
    v_cvt_pk_bf16_f32 v181, v117, v133
    v_cvt_pk_bf16_f32 v182, v118, v134
    v_cvt_pk_bf16_f32 v183, v119, v135
    v_mfma_f32_32x32x16_bf16 v[104:119], v[160:163], v[220:223], 0
    v_mul_f32 v68, v64, v38
    v_mul_f32 v69, v65, v38
    v_fma_f32 v68, -v65, v39, v68
    v_fmac_f32 v69, v64, v39
    v_cvt_pk_bf16_f32 v188, v48, v50
    buffer_load_dwordx4 v7, s[52:55], s77 offen offset:1024 lds
    v_cvt_pk_bf16_f32 v189, v52, v54
    v_mfma_f32_32x32x16_bf16 v[104:119], v[168:171], v[224:227], v[104:119]
    v_cvt_pk_bf16_f32 v190, v64, v64
    v_cvt_pk_bf16_f32 v191, v66, v68
    v_mul_f32 v56, v48, v38
    v_mul_f32 v57, v49, v38
    v_fma_f32 v56, -v49, v39, v56
    v_fmac_f32 v57, v48, v39
    v_mfma_f32_32x32x16_bf16 v[120:135], v[176:179], v[220:223], 0
    v_mul_f32 v58, v50, v38
    v_mul_f32 v59, v51, v38
    v_fma_f32 v58, -v51, v39, v58
    s_barrier
    s_add_u32 m0, s69, 57344
    s_add_u32 s76, s76, s74
    buffer_load_dwordx4 v136, s[52:55], s76 offen offset:0 lds
    v_fmac_f32 v59, v50, v39
    v_mul_f32 v60, v52, v38
    v_mul_f32 v61, v53, v38
    v_mfma_f32_32x32x16_bf16 v[120:135], v[184:187], v[224:227], v[120:135]
    v_fma_f32 v60, -v53, v39, v60
    v_fmac_f32 v61, v52, v39
    v_cvt_pk_bf16_f32 v204, -v49, -v51
    v_cvt_pk_bf16_f32 v205, -v53, -v55
    v_cvt_pk_bf16_f32 v206, -v65, -v65
    v_cvt_pk_bf16_f32 v207, -v67, -v69
    v_mul_f32 v62, v54, v38
    v_mul_f32 v63, v55, v38
    s_add_u32 m0, s68, 32768
    s_lshl_b32 s75, s78, 7
    s_add_u32 s75, s75, s73
    buffer_load_dwordx4 v4, s[48:51], s75 offen offset:0 lds
    v_fma_f32 v62, -v55, v39, v62
    v_fmac_f32 v63, v54, v39
    v_mul_f32 v70, v68, v36
    v_mul_f32 v71, v69, v36
    v_cvt_pk_bf16_f32 v160, v104, v120
    v_cvt_pk_bf16_f32 v161, v105, v121
    v_cvt_pk_bf16_f32 v162, v106, v122
    v_cvt_pk_bf16_f32 v163, v107, v123
    v_cvt_pk_bf16_f32 v168, v108, v124
    v_cvt_pk_bf16_f32 v169, v109, v125
    v_cvt_pk_bf16_f32 v170, v110, v126
    v_cvt_pk_bf16_f32 v171, v111, v127
    buffer_load_dwordx4 v5, s[48:51], s75 offen offset:1024 lds
    v_cvt_pk_bf16_f32 v176, v112, v128
    v_cvt_pk_bf16_f32 v177, v113, v129
    v_cvt_pk_bf16_f32 v178, v114, v130
    v_cvt_pk_bf16_f32 v179, v115, v131
    v_cvt_pk_bf16_f32 v184, v116, v132
    v_cvt_pk_bf16_f32 v185, v117, v133
    v_cvt_pk_bf16_f32 v186, v118, v134
    v_cvt_pk_bf16_f32 v187, v119, v135
    v_fma_f32 v70, -v69, v37, v70
    v_fmac_f32 v71, v68, v37
    v_mul_f32 v72, v64, v40
    v_mul_f32 v73, v65, v40
    s_add_u32 s75, s75, 14336
    buffer_load_dwordx4 v4, s[48:51], s75 offen offset:2048 lds
    v_fma_f32 v72, -v65, v41, v72
    v_fmac_f32 v73, v64, v41
    v_cvt_pk_bf16_f32 v192, v56, v58
    v_cvt_pk_bf16_f32 v193, v60, v62
    v_cvt_pk_bf16_f32 v194, v68, v68
    v_cvt_pk_bf16_f32 v195, v70, v72
    v_mul_f32 v74, v64, v34
    v_mul_f32 v75, v65, v34
    v_fma_f32 v74, -v65, v35, v74
    v_fmac_f32 v75, v64, v35
    v_mul_f32 v76, v74, v38
    v_mul_f32 v77, v75, v38
    buffer_load_dwordx4 v5, s[48:51], s75 offen offset:3072 lds
    v_fma_f32 v76, -v75, v39, v76
    v_fmac_f32 v77, v74, v39
    v_mul_f32 v78, v74, v40
    v_mul_f32 v79, v75, v40
    v_fma_f32 v78, -v75, v41, v78
    v_fmac_f32 v79, v74, v41
    v_mul_f32 v80, v74, v34
    v_mul_f32 v81, v75, v34
    v_fma_f32 v80, -v75, v35, v80
    v_fmac_f32 v81, v74, v35
    v_cvt_pk_bf16_f32 v208, -v57, -v59
    v_cvt_pk_bf16_f32 v209, -v61, -v63
    s_add_u32 m0, s72, 81920
    s_add_u32 s78, s6, 4
    s_and_b32 s78, s78, 7
    s_mul_i32 s76, s78, 196608
    s_add_u32 s77, s76, s70
    buffer_load_dwordx4 v6, s[52:55], s77 offen offset:0 lds
    v_cvt_pk_bf16_f32 v210, -v69, -v69
    v_cvt_pk_bf16_f32 v211, -v71, -v73
    v_mul_f32 v82, v80, v38
    v_mul_f32 v83, v81, v38
    v_fma_f32 v82, -v81, v39, v82
    v_fmac_f32 v83, v80, v39
    v_mul_f32 v84, v80, v40
    v_mul_f32 v85, v81, v40
    v_fma_f32 v84, -v81, v41, v84
    v_fmac_f32 v85, v80, v41
    v_mul_f32 v86, v80, v34
    v_mul_f32 v87, v81, v34
    buffer_load_dwordx4 v7, s[52:55], s77 offen offset:1024 lds
    v_fma_f32 v86, -v81, v35, v86
    v_fmac_f32 v87, v80, v35
    v_mul_f32 v90, v86, v34
    v_mul_f32 v91, v87, v34
    v_fma_f32 v90, -v87, v35, v90
    v_fmac_f32 v91, v86, v35
    v_cvt_pk_bf16_f32 v196, v74, v76
    v_cvt_pk_bf16_f32 v197, v78, v86
    v_cvt_pk_bf16_f32 v198, v80, v82
    v_cvt_pk_bf16_f32 v199, v84, v90
    v_mul_f32 v88, v86, v40
    v_mul_f32 v89, v87, v40
    s_waitcnt vmcnt(9)
    s_barrier
    s_add_u32 m0, s69, 90112
    s_add_u32 s76, s76, s74
    buffer_load_dwordx4 v136, s[52:55], s76 offen offset:0 lds
    v_fma_f32 v88, -v87, v41, v88
    v_fmac_f32 v89, v86, v41
    v_mul_f32 v92, v90, v40
    v_mul_f32 v93, v91, v40
    v_fma_f32 v92, -v91, v41, v92
    v_fmac_f32 v93, v90, v41
    v_mul_f32 v94, v90, v34
    v_mul_f32 v95, v91, v34
    v_fma_f32 v94, -v91, v35, v94
    v_fmac_f32 v95, v90, v35
    v_cvt_pk_bf16_f32 v212, -v75, -v77
    v_cvt_pk_bf16_f32 v213, -v79, -v87
    s_add_u32 m0, s68, 65536
    s_lshl_b32 s75, s78, 7
    s_add_u32 s75, s75, s73
    buffer_load_dwordx4 v4, s[48:51], s75 offen offset:0 lds
    v_cvt_pk_bf16_f32 v214, -v81, -v83
    v_cvt_pk_bf16_f32 v215, -v85, -v91
    v_mul_f32 v96, v94, v40
    v_mul_f32 v97, v95, v40
    v_fma_f32 v96, -v95, v41, v96
    v_fmac_f32 v97, v94, v41
    v_mul_f32 v98, v94, v34
    v_mul_f32 v99, v95, v34
    v_fma_f32 v98, -v95, v35, v98
    v_fmac_f32 v99, v94, v35
    v_mul_f32 v100, v98, v40
    v_mul_f32 v101, v99, v40
    s_mov_b64 exec, 1
    v_mov_b32 v2, s96
    buffer_store_dword v2, off, s[56:59], s87 sc1
    s_mov_b64 exec, -1
    buffer_load_dwordx4 v5, s[48:51], s75 offen offset:1024 lds
    v_fma_f32 v100, -v99, v41, v100
    v_fmac_f32 v101, v98, v41
    v_cvt_pk_bf16_f32 v200, v88, v94
    v_cvt_pk_bf16_f32 v201, v96, v96
    v_cvt_pk_bf16_f32 v202, v92, v98
    v_cvt_pk_bf16_f32 v203, v100, v100
    v_cvt_pk_bf16_f32 v216, -v89, -v95
    v_cvt_pk_bf16_f32 v217, -v97, -v97
    v_cvt_pk_bf16_f32 v218, -v93, -v99
    v_cvt_pk_bf16_f32 v219, -v101, -v101
    v_permlane32_swap_b32 v188, v192
    v_permlane32_swap_b32 v189, v193
    s_add_u32 s75, s75, 14336
    buffer_load_dwordx4 v4, s[48:51], s75 offen offset:2048 lds
    v_permlane32_swap_b32 v190, v194
    v_permlane32_swap_b32 v191, v195
    v_permlane32_swap_b32 v196, v200
    v_permlane32_swap_b32 v197, v201
    v_permlane32_swap_b32 v198, v202
    v_permlane32_swap_b32 v199, v203
    v_permlane32_swap_b32 v204, v208
    v_permlane32_swap_b32 v205, v209
    v_permlane32_swap_b32 v206, v210
    v_permlane32_swap_b32 v207, v211
    v_permlane32_swap_b32 v212, v216
    v_permlane32_swap_b32 v213, v217
    buffer_load_dwordx4 v5, s[48:51], s75 offen offset:3072 lds
    v_permlane32_swap_b32 v214, v218
    v_permlane32_swap_b32 v215, v219
    v_mfma_f32_32x32x16_bf16 v[104:119], v[188:191], v[220:223], 0
    v_lshlrev_b32 v13, 4, v0
    v_and_b32 v1, 15, v0
    v_lshrrev_b32 v255, 5, v0
    v_lshl_add_u32 v1, v255, 4, v1
    v_lshlrev_b32 v14, 4, v1
    v_mov_b32 v12, 0xdddddddd
    v_mfma_f32_32x32x16_bf16 v[104:119], v[196:199], v[224:227], v[104:119]
    v_and_b32 v1, 27, v0
    v_cmp_eq_u32 vcc, 16, v1
    s_add_u32 m0, s72, 114688
    s_add_u32 s78, s6, 5
    s_and_b32 s78, s78, 7
    s_mul_i32 s76, s78, 196608
    s_add_u32 s77, s76, s70
    buffer_load_dwordx4 v6, s[52:55], s77 offen offset:0 lds
    v_mov_b32 v1, 0x3f803f80
    v_cndmask_b32 v1, 0, v1, vcc
    v_mov_b32 v140, v1
    v_mov_b32 v141, v1
    v_mfma_f32_32x32x16_bf16 v[120:135], v[204:207], v[220:223], 0
    v_mov_b32 v142, v1
    v_mov_b32 v143, v1
    v_mov_b32 v144, v1
    v_mov_b32 v145, v1
    v_mov_b32 v146, v1
    v_mov_b32 v147, v1
    v_mfma_f32_32x32x16_bf16 v[120:135], v[212:215], v[224:227], v[120:135]
    buffer_load_dwordx4 v7, s[52:55], s77 offen offset:1024 lds
    s_nop 10
    v_cvt_pk_bf16_f32 v188, v104, v120
    v_cvt_pk_bf16_f32 v189, v105, v121
    v_cvt_pk_bf16_f32 v190, v106, v122
    v_cvt_pk_bf16_f32 v191, v107, v123
    v_cvt_pk_bf16_f32 v196, v108, v124
    v_cvt_pk_bf16_f32 v197, v109, v125
    v_cvt_pk_bf16_f32 v198, v110, v126
    v_cvt_pk_bf16_f32 v199, v111, v127
    v_mfma_f32_32x32x16_bf16 v[32:47], v[188:191], v[156:159], 0
    v_cvt_pk_bf16_f32 v204, v112, v128
    v_cvt_pk_bf16_f32 v205, v113, v129
    v_cvt_pk_bf16_f32 v206, v114, v130
    s_waitcnt vmcnt(10)
    s_barrier
    s_add_u32 m0, s69, 122880
    s_add_u32 s76, s76, s74
    buffer_load_dwordx4 v136, s[52:55], s76 offen offset:0 lds
    v_cvt_pk_bf16_f32 v207, v115, v131
    v_mfma_f32_32x32x16_bf16 v[32:47], v[196:199], v[164:167], v[32:47]
    v_cvt_pk_bf16_f32 v212, v116, v132
    v_cvt_pk_bf16_f32 v213, v117, v133
    v_cvt_pk_bf16_f32 v214, v118, v134
    v_cvt_pk_bf16_f32 v215, v119, v135
    v_mfma_f32_32x32x16_bf16 v[32:47], v[204:207], v[172:175], v[32:47]
    s_nop 0
    v_mfma_f32_32x32x16_bf16 v[32:47], v[212:215], v[180:183], v[32:47]
    v_mfma_f32_32x32x16_bf16 v[104:119], v[192:195], v[220:223], 0
    v_mfma_f32_32x32x16_bf16 v[104:119], v[200:203], v[224:227], v[104:119]
    v_mfma_f32_32x32x16_bf16 v[120:135], v[208:211], v[220:223], 0
    v_mfma_f32_32x32x16_bf16 v[120:135], v[216:219], v[224:227], v[120:135]
    s_add_u32 m0, s68, 98304
    s_lshl_b32 s75, s78, 7
    s_add_u32 s75, s75, s73
    buffer_load_dwordx4 v4, s[48:51], s75 offen offset:0 lds
    s_nop 7
    v_cvt_pk_bf16_f32 v192, v104, v120
    v_cvt_pk_bf16_f32 v193, v105, v121
    v_cvt_pk_bf16_f32 v194, v106, v122
    v_cvt_pk_bf16_f32 v195, v107, v123
    v_cvt_pk_bf16_f32 v200, v108, v124
    v_cvt_pk_bf16_f32 v201, v109, v125
    v_cvt_pk_bf16_f32 v202, v110, v126
    v_cvt_pk_bf16_f32 v203, v111, v127
    v_mfma_f32_32x32x16_bf16 v[32:47], v[192:195], v[160:163], v[32:47]
    v_cvt_pk_bf16_f32 v208, v112, v128
    v_cvt_pk_bf16_f32 v209, v113, v129
    v_cvt_pk_bf16_f32 v210, v114, v130
    buffer_load_dwordx4 v5, s[48:51], s75 offen offset:1024 lds
    v_cvt_pk_bf16_f32 v211, v115, v131
    v_mfma_f32_32x32x16_bf16 v[32:47], v[200:203], v[168:171], v[32:47]
    v_cvt_pk_bf16_f32 v216, v116, v132
    v_cvt_pk_bf16_f32 v217, v117, v133
    v_cvt_pk_bf16_f32 v218, v118, v134
    v_cvt_pk_bf16_f32 v219, v119, v135
    v_mfma_f32_32x32x16_bf16 v[32:47], v[208:211], v[176:179], v[32:47]
    s_nop 0
    v_mfma_f32_32x32x16_bf16 v[32:47], v[216:219], v[184:187], v[32:47]
    v_mov_b32 v116, v1
    v_mov_b32 v117, v1
    v_mov_b32 v118, v1
    v_mov_b32 v119, v1
    s_add_u32 s75, s75, 14336
    buffer_load_dwordx4 v4, s[48:51], s75 offen offset:2048 lds
    v_mov_b32 v120, v1
    v_mov_b32 v121, v1
    v_mov_b32 v122, v1
    v_mov_b32 v123, v1
    v_mov_b32 v128, v1
    v_mov_b32 v129, v1
    v_mov_b32 v130, v1
    v_mov_b32 v131, v1
    v_mov_b32 v132, v1
    v_mov_b32 v133, v1
    v_mov_b32 v134, v1
    v_mov_b32 v135, v1
    buffer_load_dwordx4 v5, s[48:51], s75 offen offset:3072 lds
    v_bfe_u32 v1, v0, 4, 1
    v_lshlrev_b32 v1, 2, v1
    v_and_b32 v255, 7, v0
    v_lshlrev_b32 v233, 3, v255
    v_xor_b32 v1, v1, v255
    v_lshlrev_b32 v1, 4, v1
    v_lshrrev_b32 v255, 3, v0
    v_lshl_add_u32 v234, v255, 12, v1
    v_lshl_add_u32 v15, v255, 10, v1
    v_and_b32 v255, 1, v255
    v_lshl_add_u32 v233, v255, 8, v233
    v_lshlrev_b32 v232, 3, v0
    s_add_u32 m0, s72, 16384
    s_add_u32 s78, s6, 6
    s_and_b32 s78, s78, 7
    s_mul_i32 s76, s78, 196608
    s_add_u32 s77, s76, s70
    buffer_load_dwordx4 v6, s[52:55], s77 offen offset:0 lds
    v_lshlrev_b32 v235, 2, v0
    buffer_load_dwordx4 v7, s[52:55], s77 offen offset:1024 lds
    s_waitcnt vmcnt(9)
    s_barrier
    v_and_b32 v17, 31, v0
    v_lshlrev_b32 v17, 2, v17
    s_lshr_b32 s15, s100, 4
    s_lshl_b32 s15, s15, 7
    s_add_u32 s15, s15, 11075584
    s_add_u32 m0, s68, 0
    s_lshl_b32 s75, s78, 7
    s_add_u32 s75, s75, s73
    buffer_load_dwordx4 v4, s[48:51], s75 offen offset:0 lds
    buffer_load_dwordx4 v5, s[48:51], s75 offen offset:1024 lds
    s_add_u32 s75, s75, 14336
    buffer_load_dwordx4 v4, s[48:51], s75 offen offset:2048 lds
    buffer_load_dwordx4 v5, s[48:51], s75 offen offset:3072 lds
    s_add_u32 m0, s72, 49152
    s_add_u32 s78, s6, 7
    s_and_b32 s78, s78, 7
    s_mul_i32 s76, s78, 196608
    s_add_u32 s77, s76, s70
    buffer_load_dwordx4 v6, s[52:55], s77 offen offset:0 lds
    buffer_load_dwordx4 v7, s[52:55], s77 offen offset:1024 lds
    s_add_u32 m0, s68, 32768
    s_lshl_b32 s75, s78, 7
    s_add_u32 s75, s75, s73
    buffer_load_dwordx4 v4, s[48:51], s75 offen offset:0 lds
    buffer_load_dword v18, v17, s[56:59], s15 offen sc1
    s_waitcnt vmcnt(10)
    s_barrier
    buffer_load_dwordx4 v5, s[48:51], s75 offen offset:1024 lds
    s_add_u32 s75, s75, 14336
    buffer_load_dwordx4 v4, s[48:51], s75 offen offset:2048 lds
    buffer_load_dwordx4 v5, s[48:51], s75 offen offset:3072 lds
    s_add_u32 m0, s69, 24576
    s_add_u32 s78, s6, 6
    s_and_b32 s78, s78, 7
    s_mul_i32 s76, s78, 196608
    s_add_u32 s76, s76, s74
    buffer_load_dwordx4 v136, s[52:55], s76 offen offset:0 lds
    s_add_u32 m0, s69, 57344
    s_add_u32 s78, s6, 7
    s_and_b32 s78, s78, 7
    s_mul_i32 s76, s78, 196608
    s_add_u32 s76, s76, s74
    buffer_load_dwordx4 v136, s[52:55], s76 offen offset:0 lds
    v_cmp_eq_u32 vcc, 0, v0
    s_nop 1
    v_cndmask_b32 v27, 0, v27, vcc
    v_and_b32 v1, 3, v0
    v_sub_u32 v1, 3, v1
    v_mul_u32_u24 v1, 4160, v1
    v_bfe_u32 v2, v0, 2, 2
    v_lshl_add_u32 v1, v2, 3, v1
    v_lshrrev_b32 v2, 4, v0
    v_lshl_add_u32 v1, v2, 4, v1
    s_lshl_b32 s9, s80, 8
    s_add_u32 s8, s86, s9
    s_add_u32 s8, s8, 40
    v_add_u32 v252, s8, v1
    v_and_b32 v1, 15, v0
    v_lshlrev_b32 v1, 1, v1
    v_sub_u32 v1, v1, v2
    v_lshlrev_b32 v1, 4, v1
    s_sub_u32 s8, s85, s9
    s_add_u32 s8, s8, 16
    v_add_u32 v253, s8, v1
    s_waitcnt vmcnt(9)
    s_barrier
    v_lshlrev_b32 v16, 4, v0
    s_lshl_b32 s9, s80, 11
    s_add_u32 s8, s86, s9
    s_add_u32 s8, s8, 64
    v_add_u32 v10, s8, v16
    s_mul_i32 s14, s100, 4224
    s_add_u32 s14, s14, s9
    s_lshl_b32 s9, s80, 3
    s_sub_u32 s101, s14, s9
    s_lshl_b32 s13, s81, 2
    s_add_u32 s12, s13, 162840
    s_add_u32 s87, s13, 162824
    s_add_u32 s13, s13, 162832
    s_xor_b32 s8, s84, 8192
    v_add_u32 v246, s84, v16
    v_add_u32 v247, s8, v16
    v_and_b32 v1, 15, v0
    v_lshlrev_b32 v1, 5, v1
    v_lshrrev_b32 v2, 5, v0
    v_lshl_add_u32 v1, v2, 4, v1
    v_bfe_u32 v2, v0, 4, 1
    v_lshl_add_u32 v248, v2, 9, v1
    s_lshl_b32 s100, s100, 12
    s_lshl_b32 s9, s80, 11
    s_add_u32 s100, s100, s9
    s_add_u32 s100, s100, 6422528
    s_and_b32 s8, s5, 1
    s_lshl_b32 s9, s4, 1
    s_add_u32 s8, s8, s9
    s_lshl_b32 s8, s8, 1
    s_add_u32 s8, s8, s80
    s_lshl_b32 s84, s8, 17
    s_add_u32 s84, s84, 2228224
    s_lshl_b32 s72, s80, 12
    s_add_u32 s72, s72, 143872
    s_and_b32 s9, s5, 30
    s_add_u32 s9, s9, s82
    s_lshl_b32 s9, s9, 5
    s_add_u32 s8, s8, s9
    s_lshl_b32 s8, s8, 1
    s_add_u32 s8, s8, s81
    s_lshl_b32 s77, s8, 10
    s_add_u32 s77, s77, 8519680
    s_lshl_b32 s78, s8, 2
    s_add_u32 s78, s78, 10747904
    s_lshr_b32 s8, s5, 2
    s_lshl_b32 s8, s8, 14
    s_lshl_b32 s9, s82, 16
    s_xor_b32 s8, s8, s9
    s_lshl_b32 s9, s81, 11
    s_or_b32 s8, s8, s9
    s_or_b32 s83, s84, s8
    s_lshl_b32 s85, s3, 13
    s_lshl_b32 s8, s4, 7
    s_add_u32 s85, s85, s8
    s_lshl_b32 s86, s3, 10
    s_mov_b32 s88, 0xffff
    s_mov_b32 s89, 0xffff
    s_lshl_b32 s8, s5, 1
    s_add_u32 s8, s8, s80
    s_lshl_b32 s73, s8, 10
    s_add_u32 s73, s73, 11206656
    s_and_b32 s8, s8, 61
    s_lshl_b32 s8, s8, 7
    s_add_u32 s8, s8, 11026432
    v_add_u32 v233, s8, v233
    s_lshl_b32 s74, s4, 18
    s_lshl_b32 s8, s3, 15
    s_add_u32 s74, s74, s8
    s_lshl_b32 s8, s5, 7
    s_add_u32 s74, s74, s8
    s_add_u32 s74, s74, 6422528
    s_lshl_b32 s75, s4, 9
    s_add_u32 s75, s75, 11010048
    s_waitcnt vmcnt(2)
    s_barrier
    s_waitcnt vmcnt(0)
    v_cmp_ne_u32 vcc, s96, v18
    s_nop 1
    s_or_b32 s90, vcc_lo, vcc_hi
    s_cbranch_scc1 L_nou_15
    buffer_load_dwordx4 v[236:239], v16, s[56:59], s14 offen offset:0 sc1
    buffer_load_dwordx4 v[240:243], v16, s[56:59], s14 offen offset:1024 sc1
    buffer_load_dwordx2 v[228:229], off, s[56:59], s101 sc1
L_nou_15:
    s_cmp_lg_u32 s80, 0
    s_cbranch_scc1 L_el_16
    ds_write_b128 v249, v[40:43]
    ds_write_b128 v249, v[44:47] offset:1024
    v_add_f32 v32, v32, v27
    s_branch L_fi_17
L_el_16:
    ds_write_b128 v249, v[32:35]
    ds_write_b128 v249, v[36:39] offset:1024
L_fi_17:
    s_waitcnt lgkmcnt(0)
    s_barrier
    s_setprio 1
    ds_read_b128 v[156:159], v250
    ds_read_b128 v[160:163], v250 offset:1024
    ds_write_b64 v19, v[28:29] offset:8
    s_cmp_eq_u32 s90, 0
    s_cbranch_scc1 L_uok_18
    s_mov_b32 s8, 400000
L_pl_19:
    buffer_load_dword v18, v17, s[56:59], s15 offen sc1
L_ple_21:
    s_waitcnt vmcnt(0)
    v_cmp_ne_u32 vcc, s96, v18
    s_nop 1
    s_cbranch_vccz L_pld_20
    s_mov_b64 exec, vcc
    s_sleep 2
    s_sub_u32 s8, s8, 1
    s_cmp_lg_u32 s8, 0
    s_cbranch_scc1 L_pl_19
L_pld_20:
    s_mov_b64 exec, -1
    buffer_load_dwordx4 v[236:239], v16, s[56:59], s14 offen offset:0 sc1
    buffer_load_dwordx4 v[240:243], v16, s[56:59], s14 offen offset:1024 sc1
    buffer_load_dwordx2 v[228:229], off, s[56:59], s101 sc1
L_uok_18:
    s_waitcnt lgkmcnt(1)
    s_cmp_lg_u32 s80, 0
    s_cbranch_scc1 L_el_22
    v_add_f32 v32, v32, v156
    v_add_f32 v33, v33, v157
    v_add_f32 v34, v34, v158
    v_add_f32 v35, v35, v159
    v_add_f32 v36, v36, v160
    v_add_f32 v37, v37, v161
    v_add_f32 v38, v38, v162
    v_add_f32 v39, v39, v163
    v_cvt_pk_bf16_f32 v156, v39, v38
    v_cvt_pk_bf16_f32 v157, v37, v36
    v_cvt_pk_bf16_f32 v158, v35, v34
    v_cvt_pk_bf16_f32 v159, v33, v32
    ds_write_b128 v251, v[156:159] offset:512
    s_branch L_fi_23
L_el_22:
    v_add_f32 v40, v40, v156
    v_add_f32 v41, v41, v157
    v_add_f32 v42, v42, v158
    v_add_f32 v43, v43, v159
    v_add_f32 v44, v44, v160
    v_add_f32 v45, v45, v161
    v_add_f32 v46, v46, v162
    v_cvt_pk_bf16_f32 v156, v42, v42
    v_cvt_pk_bf16_f32 v157, v41, v41
    v_cvt_pk_bf16_f32 v158, v41, v40
    v_cvt_pk_bf16_f32 v159, v40, v40
    ds_write_b128 v251, v[156:159] offset:1536
    v_cndmask_b32 v32, v43, v44, s[10:11]
    v_cvt_pk_bf16_f32 v160, v44, v44
    v_cvt_pk_bf16_f32 v161, v44, v32
    v_cvt_pk_bf16_f32 v162, v43, v43
    v_cvt_pk_bf16_f32 v163, v43, v43
    ds_write_b128 v251, v[160:163] offset:2560
    v_cndmask_b32 v32, v45, v46, s[10:11]
    v_cvt_pk_bf16_f32 v164, v46, v46
    v_cvt_pk_bf16_f32 v165, v46, v32
    v_cvt_pk_bf16_f32 v166, v45, v45
    v_cvt_pk_bf16_f32 v167, v45, v45
    ds_write_b128 v251, v[164:167] offset:3584
L_fi_23:
    s_waitcnt vmcnt(0)
    v_mul_lo_u32 v228, v228, s80
    v_mul_lo_u32 v229, v229, s80
    v_mov_b32_dpp v230, v238 wave_ror:1 row_mask:0xf bank_mask:0xf
    v_mov_b32_dpp v231, v239 wave_ror:1 row_mask:0xf bank_mask:0xf
    v_mov_b32_dpp v228, v238 wave_shr:1 row_mask:0xf bank_mask:0xf
    v_mov_b32_dpp v229, v239 wave_shr:1 row_mask:0xf bank_mask:0xf
    v_alignbit_b32 v191, v239, v238, 16
    v_alignbit_b32 v190, v238, v237, 16
    v_alignbit_b32 v189, v237, v236, 16
    v_alignbit_b32 v188, v236, v229, 16
    v_mov_b32 v192, v229
    v_mov_b32 v193, v236
    v_mov_b32 v194, v237
    v_mov_b32 v195, v238
    v_alignbit_b32 v196, v229, v228, 16
    v_alignbit_b32 v197, v236, v229, 16
    v_alignbit_b32 v198, v237, v236, 16
    v_alignbit_b32 v199, v238, v237, 16
    ds_write_b128 v10, v[236:239] offset:0
    v_mov_b32_dpp v230, v242 wave_shr:1 row_mask:0xf bank_mask:0xf
    v_mov_b32_dpp v231, v243 wave_shr:1 row_mask:0xf bank_mask:0xf
    v_alignbit_b32 v203, v243, v242, 16
    v_alignbit_b32 v202, v242, v241, 16
    ds_write_b128 v10, v[188:191] offset:4160
    v_alignbit_b32 v201, v241, v240, 16
    v_alignbit_b32 v200, v240, v231, 16
    v_mov_b32 v204, v231
    v_mov_b32 v205, v240
    ds_write_b128 v10, v[192:195] offset:8320
    v_mov_b32 v206, v241
    v_mov_b32 v207, v242
    v_alignbit_b32 v208, v231, v230, 16
    v_alignbit_b32 v209, v240, v231, 16
    ds_write_b128 v10, v[196:199] offset:12480
    v_alignbit_b32 v210, v241, v240, 16
    v_alignbit_b32 v211, v242, v241, 16
    ds_write_b128 v10, v[240:243] offset:1024
    ds_write_b128 v10, v[200:203] offset:5184
    ds_write_b128 v10, v[204:207] offset:9344
    ds_write_b128 v10, v[208:211] offset:13504
    s_mov_b64 exec, 1
    v_mov_b32 v1, s13
    v_mov_b32 v2, 1
    ds_add_u32 v1, v2
    s_mov_b64 exec, -1
    s_lshl_b32 s8, s7, 2
    s_add_u32 s8, s8, s79
    s_lshl_b32 s8, s8, 9
    v_and_b32 v1, 3, v0
    v_lshlrev_b32 v1, 7, v1
    buffer_load_dword v254, v1, s[60:63], s8 offen
    v_mfma_f32_32x32x16_bf16 v[48:63], v[28:31], v[28:31], 0
    v_mfma_f32_32x32x16_bf16 v[64:79], v[28:31], v[28:31], 0
    v_mfma_f32_32x32x16_bf16 v[80:95], v[28:31], v[28:31], 0
    v_mfma_f32_32x32x16_bf16 v[96:111], v[28:31], v[28:31], 0
    v_mov_b32 v1, s13
    s_mov_b32 s8, 3200000
L_lw_24:
    ds_read_b32 v2, v1
    s_waitcnt lgkmcnt(0)
    v_readfirstlane_b32 s9, v2
    s_nop 1
    s_cmp_ge_u32 s9, 2
    s_cbranch_scc1 L_lwd_25
    s_sleep 1
    s_sub_u32 s8, s8, 1
    s_cmp_lg_u32 s8, 0
    s_cbranch_scc1 L_lw_24
L_lwd_25:
    s_setprio 2
    ds_read_b64 v[196:197], v252 offset:0
    ds_read_b64 v[198:199], v252 offset:8
    ds_read_b128 v[16:19], v253 offset:4096
    ds_read_b128 v[20:23], v253 offset:3584
    ds_read_b128 v[24:27], v253 offset:3072
    ds_read_b128 v[28:31], v253 offset:2560
    ds_read_b128 v[32:35], v253 offset:2048
    ds_read_b128 v[36:39], v253 offset:1536
    ds_read_b128 v[40:43], v253 offset:1024
    ds_read_b128 v[44:47], v253 offset:512
    ds_read_b64 v[200:201], v252 offset:512
    ds_read_b64 v[202:203], v252 offset:520
    s_xor_b32 s8, s4, 1
    v_and_b32 v1, 1, v0
    v_mul_u32_u24 v1, 3, v1
    v_xor_b32 v1, s8, v1
    v_and_b32 v228, 31, v0
    v_lshl_add_u32 v228, v1, 5, v228
    v_mul_u32_u24 v228, 128, v228
    v_add_u32 v228, 12582912, v228
    s_waitcnt lgkmcnt(6)
    v_mfma_f32_16x16x32_bf16 v[184:187], v[196:199], v[16:19], 0
    ds_read_b64 v[204:205], v252 offset:1024
    v_mfma_f32_16x16x32_bf16 v[180:183], v[196:199], v[20:23], 0
    ds_read_b64 v[206:207], v252 offset:1032
    v_mfma_f32_16x16x32_bf16 v[176:179], v[196:199], v[24:27], 0
    ds_read_b64 v[208:209], v252 offset:1536
    v_mfma_f32_16x16x32_bf16 v[172:175], v[196:199], v[28:31], 0
    ds_read_b64 v[210:211], v252 offset:1544
    s_waitcnt lgkmcnt(6)
    v_mfma_f32_16x16x32_bf16 v[168:171], v[196:199], v[32:35], 0
    ds_read_b64 v[212:213], v252 offset:2048
    v_mfma_f32_16x16x32_bf16 v[164:167], v[196:199], v[36:39], 0
    ds_read_b64 v[214:215], v252 offset:2056
    v_mfma_f32_16x16x32_bf16 v[160:163], v[196:199], v[40:43], 0
    ds_read_b64 v[216:217], v252 offset:2560
    v_mfma_f32_16x16x32_bf16 v[156:159], v[196:199], v[44:47], 0
    ds_read_b64 v[218:219], v252 offset:2568
    s_waitcnt lgkmcnt(6)
    v_mfma_f32_16x16x32_bf16 v[184:187], v[200:203], v[20:23], v[184:187]
    ds_read_b64 v[196:197], v252 offset:3072
    v_mfma_f32_16x16x32_bf16 v[180:183], v[200:203], v[24:27], v[180:183]
    ds_read_b64 v[198:199], v252 offset:3080
    v_mfma_f32_16x16x32_bf16 v[176:179], v[200:203], v[28:31], v[176:179]
    v_mfma_f32_16x16x32_bf16 v[172:175], v[200:203], v[32:35], v[172:175]
    v_mfma_f32_16x16x32_bf16 v[168:171], v[200:203], v[36:39], v[168:171]
    v_mfma_f32_16x16x32_bf16 v[164:167], v[200:203], v[40:43], v[164:167]
    v_mfma_f32_16x16x32_bf16 v[160:163], v[200:203], v[44:47], v[160:163]
    ds_read_b64 v[200:201], v252 offset:3584
    v_mfma_f32_16x16x32_bf16 v[184:187], v[204:207], v[24:27], v[184:187]
    ds_read_b64 v[202:203], v252 offset:3592
    v_mfma_f32_16x16x32_bf16 v[180:183], v[204:207], v[28:31], v[180:183]
    v_mfma_f32_16x16x32_bf16 v[176:179], v[204:207], v[32:35], v[176:179]
    v_mfma_f32_16x16x32_bf16 v[172:175], v[204:207], v[36:39], v[172:175]
    v_mfma_f32_16x16x32_bf16 v[168:171], v[204:207], v[40:43], v[168:171]
    v_mfma_f32_16x16x32_bf16 v[164:167], v[204:207], v[44:47], v[164:167]
    ds_read_b64 v[204:205], v252 offset:64
    s_waitcnt lgkmcnt(6)
    v_mfma_f32_16x16x32_bf16 v[184:187], v[208:211], v[28:31], v[184:187]
    ds_read_b64 v[206:207], v252 offset:72
    v_mfma_f32_16x16x32_bf16 v[180:183], v[208:211], v[32:35], v[180:183]
    ds_read_b128 v[188:191], v253 offset:4032
    v_mfma_f32_16x16x32_bf16 v[176:179], v[208:211], v[36:39], v[176:179]
    ds_read_b128 v[192:195], v253 offset:3520
    v_mfma_f32_16x16x32_bf16 v[172:175], v[208:211], v[40:43], v[172:175]
    ds_read_b128 v[16:19], v253 offset:3008
    v_mfma_f32_16x16x32_bf16 v[168:171], v[208:211], v[44:47], v[168:171]
    ds_read_b128 v[20:23], v253 offset:2496
    v_mfma_f32_16x16x32_bf16 v[184:187], v[212:215], v[32:35], v[184:187]
    ds_read_b128 v[24:27], v253 offset:1984
    v_mfma_f32_16x16x32_bf16 v[180:183], v[212:215], v[36:39], v[180:183]
    ds_read_b128 v[28:31], v253 offset:1472
    v_mfma_f32_16x16x32_bf16 v[176:179], v[212:215], v[40:43], v[176:179]
    v_mfma_f32_16x16x32_bf16 v[172:175], v[212:215], v[44:47], v[172:175]
    s_waitcnt lgkmcnt(6)
    v_mfma_f32_16x16x32_bf16 v[184:187], v[216:219], v[36:39], v[184:187]
    ds_read_b128 v[32:35], v253 offset:960
    v_mfma_f32_16x16x32_bf16 v[180:183], v[216:219], v[40:43], v[180:183]
    ds_read_b128 v[36:39], v253 offset:448
    v_mfma_f32_16x16x32_bf16 v[176:179], v[216:219], v[44:47], v[176:179]
    ds_read_b64 v[208:209], v252 offset:576
    v_mfma_f32_16x16x32_bf16 v[184:187], v[196:199], v[40:43], v[184:187]
    ds_read_b64 v[210:211], v252 offset:584
    v_mfma_f32_16x16x32_bf16 v[180:183], v[196:199], v[44:47], v[180:183]
    ds_read_b64 v[212:213], v252 offset:1088
    v_mfma_f32_16x16x32_bf16 v[184:187], v[200:203], v[44:47], v[184:187]
    ds_read_b64 v[214:215], v252 offset:1096
    s_waitcnt lgkmcnt(6)
    v_mfma_f32_16x16x32_bf16 v[184:187], v[204:207], v[188:191], v[184:187]
    ds_read_b64 v[216:217], v252 offset:1600
    v_mfma_f32_16x16x32_bf16 v[180:183], v[204:207], v[192:195], v[180:183]
    ds_read_b64 v[218:219], v252 offset:1608
    v_mfma_f32_16x16x32_bf16 v[176:179], v[204:207], v[16:19], v[176:179]
    ds_read_b64 v[196:197], v252 offset:2112
    v_mfma_f32_16x16x32_bf16 v[172:175], v[204:207], v[20:23], v[172:175]
    ds_read_b64 v[198:199], v252 offset:2120
    v_mfma_f32_16x16x32_bf16 v[168:171], v[204:207], v[24:27], v[168:171]
    ds_read_b64 v[200:201], v252 offset:2624
    v_mfma_f32_16x16x32_bf16 v[164:167], v[204:207], v[28:31], v[164:167]
    ds_read_b64 v[202:203], v252 offset:2632
    s_waitcnt lgkmcnt(6)
    v_mfma_f32_16x16x32_bf16 v[160:163], v[204:207], v[32:35], v[160:163]
    v_mfma_f32_16x16x32_bf16 v[156:159], v[204:207], v[36:39], v[156:159]
    ds_read_b64 v[204:205], v252 offset:3136
    v_mfma_f32_16x16x32_bf16 v[184:187], v[208:211], v[192:195], v[184:187]
    ds_read_b64 v[206:207], v252 offset:3144
    v_mfma_f32_16x16x32_bf16 v[180:183], v[208:211], v[16:19], v[180:183]
    v_mfma_f32_16x16x32_bf16 v[176:179], v[208:211], v[20:23], v[176:179]
    v_mfma_f32_16x16x32_bf16 v[172:175], v[208:211], v[24:27], v[172:175]
    v_mfma_f32_16x16x32_bf16 v[168:171], v[208:211], v[28:31], v[168:171]
    v_mfma_f32_16x16x32_bf16 v[164:167], v[208:211], v[32:35], v[164:167]
    v_mfma_f32_16x16x32_bf16 v[160:163], v[208:211], v[36:39], v[160:163]
    ds_read_b64 v[208:209], v252 offset:3648
    v_mfma_f32_16x16x32_bf16 v[184:187], v[212:215], v[16:19], v[184:187]
    ds_read_b64 v[210:211], v252 offset:3656
    v_mfma_f32_16x16x32_bf16 v[180:183], v[212:215], v[20:23], v[180:183]
    v_mfma_f32_16x16x32_bf16 v[176:179], v[212:215], v[24:27], v[176:179]
    v_mfma_f32_16x16x32_bf16 v[172:175], v[212:215], v[28:31], v[172:175]
    v_mfma_f32_16x16x32_bf16 v[168:171], v[212:215], v[32:35], v[168:171]
    v_mfma_f32_16x16x32_bf16 v[164:167], v[212:215], v[36:39], v[164:167]
    ds_read_b64 v[212:213], v252 offset:128
    s_waitcnt lgkmcnt(6)
    v_mfma_f32_16x16x32_bf16 v[184:187], v[216:219], v[20:23], v[184:187]
    ds_read_b64 v[214:215], v252 offset:136
    v_mfma_f32_16x16x32_bf16 v[180:183], v[216:219], v[24:27], v[180:183]
    ds_read_b128 v[40:43], v253 offset:3968
    v_mfma_f32_16x16x32_bf16 v[176:179], v[216:219], v[28:31], v[176:179]
    ds_read_b128 v[44:47], v253 offset:3456
    v_mfma_f32_16x16x32_bf16 v[172:175], v[216:219], v[32:35], v[172:175]
    ds_read_b128 v[188:191], v253 offset:2944
    v_mfma_f32_16x16x32_bf16 v[168:171], v[216:219], v[36:39], v[168:171]
    ds_read_b128 v[192:195], v253 offset:2432
    v_mfma_f32_16x16x32_bf16 v[184:187], v[196:199], v[24:27], v[184:187]
    ds_read_b128 v[16:19], v253 offset:1920
    v_mfma_f32_16x16x32_bf16 v[180:183], v[196:199], v[28:31], v[180:183]
    ds_read_b128 v[20:23], v253 offset:1408
    v_mfma_f32_16x16x32_bf16 v[176:179], v[196:199], v[32:35], v[176:179]
    v_mfma_f32_16x16x32_bf16 v[172:175], v[196:199], v[36:39], v[172:175]
    s_waitcnt lgkmcnt(6)
    v_mfma_f32_16x16x32_bf16 v[184:187], v[200:203], v[28:31], v[184:187]
    ds_read_b128 v[24:27], v253 offset:896
    v_mfma_f32_16x16x32_bf16 v[180:183], v[200:203], v[32:35], v[180:183]
    ds_read_b128 v[28:31], v253 offset:384
    v_mfma_f32_16x16x32_bf16 v[176:179], v[200:203], v[36:39], v[176:179]
    ds_read_b64 v[216:217], v252 offset:640
    v_mfma_f32_16x16x32_bf16 v[184:187], v[204:207], v[32:35], v[184:187]
    ds_read_b64 v[218:219], v252 offset:648
    v_mfma_f32_16x16x32_bf16 v[180:183], v[204:207], v[36:39], v[180:183]
    ds_read_b64 v[196:197], v252 offset:1152
    v_mfma_f32_16x16x32_bf16 v[184:187], v[208:211], v[36:39], v[184:187]
    ds_read_b64 v[198:199], v252 offset:1160
    s_waitcnt lgkmcnt(6)
    v_mfma_f32_16x16x32_bf16 v[184:187], v[212:215], v[40:43], v[184:187]
    ds_read_b64 v[200:201], v252 offset:1664
    v_mfma_f32_16x16x32_bf16 v[180:183], v[212:215], v[44:47], v[180:183]
    ds_read_b64 v[202:203], v252 offset:1672
    v_mfma_f32_16x16x32_bf16 v[176:179], v[212:215], v[188:191], v[176:179]
    ds_read_b64 v[204:205], v252 offset:2176
    v_mfma_f32_16x16x32_bf16 v[172:175], v[212:215], v[192:195], v[172:175]
    ds_read_b64 v[206:207], v252 offset:2184
    v_mfma_f32_16x16x32_bf16 v[168:171], v[212:215], v[16:19], v[168:171]
    ds_read_b64 v[208:209], v252 offset:2688
    v_mfma_f32_16x16x32_bf16 v[164:167], v[212:215], v[20:23], v[164:167]
    ds_read_b64 v[210:211], v252 offset:2696
    s_waitcnt lgkmcnt(6)
    v_mfma_f32_16x16x32_bf16 v[160:163], v[212:215], v[24:27], v[160:163]
    v_mfma_f32_16x16x32_bf16 v[156:159], v[212:215], v[28:31], v[156:159]
    ds_read_b64 v[212:213], v252 offset:3200
    v_mfma_f32_16x16x32_bf16 v[184:187], v[216:219], v[44:47], v[184:187]
    ds_read_b64 v[214:215], v252 offset:3208
    v_mfma_f32_16x16x32_bf16 v[180:183], v[216:219], v[188:191], v[180:183]
    v_mfma_f32_16x16x32_bf16 v[176:179], v[216:219], v[192:195], v[176:179]
    v_mfma_f32_16x16x32_bf16 v[172:175], v[216:219], v[16:19], v[172:175]
    v_mfma_f32_16x16x32_bf16 v[168:171], v[216:219], v[20:23], v[168:171]
    v_mfma_f32_16x16x32_bf16 v[164:167], v[216:219], v[24:27], v[164:167]
    v_mfma_f32_16x16x32_bf16 v[160:163], v[216:219], v[28:31], v[160:163]
    ds_read_b64 v[216:217], v252 offset:3712
    v_mfma_f32_16x16x32_bf16 v[184:187], v[196:199], v[188:191], v[184:187]
    ds_read_b64 v[218:219], v252 offset:3720
    v_mfma_f32_16x16x32_bf16 v[180:183], v[196:199], v[192:195], v[180:183]
    v_mfma_f32_16x16x32_bf16 v[176:179], v[196:199], v[16:19], v[176:179]
    v_mfma_f32_16x16x32_bf16 v[172:175], v[196:199], v[20:23], v[172:175]
    v_mfma_f32_16x16x32_bf16 v[168:171], v[196:199], v[24:27], v[168:171]
    v_mfma_f32_16x16x32_bf16 v[164:167], v[196:199], v[28:31], v[164:167]
    ds_read_b64 v[196:197], v252 offset:192
    s_waitcnt lgkmcnt(6)
    v_mfma_f32_16x16x32_bf16 v[184:187], v[200:203], v[192:195], v[184:187]
    ds_read_b64 v[198:199], v252 offset:200
    v_mfma_f32_16x16x32_bf16 v[180:183], v[200:203], v[16:19], v[180:183]
    ds_read_b128 v[32:35], v253 offset:3904
    v_mfma_f32_16x16x32_bf16 v[176:179], v[200:203], v[20:23], v[176:179]
    ds_read_b128 v[36:39], v253 offset:3392
    v_mfma_f32_16x16x32_bf16 v[172:175], v[200:203], v[24:27], v[172:175]
    ds_read_b128 v[40:43], v253 offset:2880
    v_mfma_f32_16x16x32_bf16 v[168:171], v[200:203], v[28:31], v[168:171]
    ds_read_b128 v[44:47], v253 offset:2368
    v_mfma_f32_16x16x32_bf16 v[184:187], v[204:207], v[16:19], v[184:187]
    ds_read_b128 v[188:191], v253 offset:1856
    v_mfma_f32_16x16x32_bf16 v[180:183], v[204:207], v[20:23], v[180:183]
    ds_read_b128 v[192:195], v253 offset:1344
    v_mfma_f32_16x16x32_bf16 v[176:179], v[204:207], v[24:27], v[176:179]
    v_mfma_f32_16x16x32_bf16 v[172:175], v[204:207], v[28:31], v[172:175]
    s_waitcnt lgkmcnt(6)
    v_mfma_f32_16x16x32_bf16 v[184:187], v[208:211], v[20:23], v[184:187]
    ds_read_b128 v[16:19], v253 offset:832
    v_mfma_f32_16x16x32_bf16 v[180:183], v[208:211], v[24:27], v[180:183]
    ds_read_b128 v[20:23], v253 offset:320
    v_mfma_f32_16x16x32_bf16 v[176:179], v[208:211], v[28:31], v[176:179]
    ds_read_b64 v[200:201], v252 offset:704
    v_mfma_f32_16x16x32_bf16 v[184:187], v[212:215], v[24:27], v[184:187]
    ds_read_b64 v[202:203], v252 offset:712
    v_mfma_f32_16x16x32_bf16 v[180:183], v[212:215], v[28:31], v[180:183]
    ds_read_b64 v[204:205], v252 offset:1216
    v_mfma_f32_16x16x32_bf16 v[184:187], v[216:219], v[28:31], v[184:187]
    ds_read_b64 v[206:207], v252 offset:1224
    s_waitcnt lgkmcnt(6)
    v_mfma_f32_16x16x32_bf16 v[184:187], v[196:199], v[32:35], v[184:187]
    ds_read_b64 v[208:209], v252 offset:1728
    v_mfma_f32_16x16x32_bf16 v[180:183], v[196:199], v[36:39], v[180:183]
    ds_read_b64 v[210:211], v252 offset:1736
    v_mfma_f32_16x16x32_bf16 v[176:179], v[196:199], v[40:43], v[176:179]
    ds_read_b64 v[212:213], v252 offset:2240
    v_mfma_f32_16x16x32_bf16 v[172:175], v[196:199], v[44:47], v[172:175]
    ds_read_b64 v[214:215], v252 offset:2248
    v_mfma_f32_16x16x32_bf16 v[168:171], v[196:199], v[188:191], v[168:171]
    ds_read_b64 v[216:217], v252 offset:2752
    v_mfma_f32_16x16x32_bf16 v[164:167], v[196:199], v[192:195], v[164:167]
    ds_read_b64 v[218:219], v252 offset:2760
    s_waitcnt lgkmcnt(6)
    v_mfma_f32_16x16x32_bf16 v[160:163], v[196:199], v[16:19], v[160:163]
    v_mfma_f32_16x16x32_bf16 v[156:159], v[196:199], v[20:23], v[156:159]
    ds_read_b64 v[196:197], v252 offset:3264
    v_mfma_f32_16x16x32_bf16 v[184:187], v[200:203], v[36:39], v[184:187]
    ds_read_b64 v[198:199], v252 offset:3272
    v_mfma_f32_16x16x32_bf16 v[180:183], v[200:203], v[40:43], v[180:183]
    v_mfma_f32_16x16x32_bf16 v[176:179], v[200:203], v[44:47], v[176:179]
    v_mfma_f32_16x16x32_bf16 v[172:175], v[200:203], v[188:191], v[172:175]
    s_cmp_lg_u32 s79, 0
    s_cbranch_scc1 L_w4_26
    buffer_load_dword v229, v228, s[56:59], 0 offen sc1
L_w4_26:
    v_mfma_f32_16x16x32_bf16 v[168:171], v[200:203], v[192:195], v[168:171]
    v_mfma_f32_16x16x32_bf16 v[164:167], v[200:203], v[16:19], v[164:167]
    v_mfma_f32_16x16x32_bf16 v[160:163], v[200:203], v[20:23], v[160:163]
    ds_read_b64 v[200:201], v252 offset:3776
    v_mfma_f32_16x16x32_bf16 v[184:187], v[204:207], v[40:43], v[184:187]
    ds_read_b64 v[202:203], v252 offset:3784
    v_mfma_f32_16x16x32_bf16 v[180:183], v[204:207], v[44:47], v[180:183]
    v_mfma_f32_16x16x32_bf16 v[176:179], v[204:207], v[188:191], v[176:179]
    v_mfma_f32_16x16x32_bf16 v[172:175], v[204:207], v[192:195], v[172:175]
    v_mfma_f32_16x16x32_bf16 v[168:171], v[204:207], v[16:19], v[168:171]
    v_mfma_f32_16x16x32_bf16 v[164:167], v[204:207], v[20:23], v[164:167]
    s_waitcnt lgkmcnt(6)
    v_mfma_f32_16x16x32_bf16 v[184:187], v[208:211], v[44:47], v[184:187]
    v_mfma_f32_16x16x32_bf16 v[180:183], v[208:211], v[188:191], v[180:183]
    v_mfma_f32_16x16x32_bf16 v[176:179], v[208:211], v[192:195], v[176:179]
    v_mfma_f32_16x16x32_bf16 v[172:175], v[208:211], v[16:19], v[172:175]
    v_mfma_f32_16x16x32_bf16 v[168:171], v[208:211], v[20:23], v[168:171]
    v_mfma_f32_16x16x32_bf16 v[184:187], v[212:215], v[188:191], v[184:187]
    v_mfma_f32_16x16x32_bf16 v[180:183], v[212:215], v[192:195], v[180:183]
    v_mfma_f32_16x16x32_bf16 v[176:179], v[212:215], v[16:19], v[176:179]
    v_mfma_f32_16x16x32_bf16 v[172:175], v[212:215], v[20:23], v[172:175]
    s_waitcnt lgkmcnt(4)
    v_mfma_f32_16x16x32_bf16 v[184:187], v[216:219], v[192:195], v[184:187]
    v_mfma_f32_16x16x32_bf16 v[180:183], v[216:219], v[16:19], v[180:183]
    v_mfma_f32_16x16x32_bf16 v[176:179], v[216:219], v[20:23], v[176:179]
    s_waitcnt lgkmcnt(2)
    v_mfma_f32_16x16x32_bf16 v[184:187], v[196:199], v[16:19], v[184:187]
    v_mfma_f32_16x16x32_bf16 v[180:183], v[196:199], v[20:23], v[180:183]
    s_waitcnt lgkmcnt(0)
    v_mfma_f32_16x16x32_bf16 v[184:187], v[200:203], v[20:23], v[184:187]
    s_setprio 3
    s_cmp_lg_u32 s79, 0
    s_cbranch_scc1 L_w4_27
    s_mov_b32 s8, 400000
    s_branch L_ple_30
L_pl_28:
    buffer_load_dword v229, v228, s[56:59], 0 offen sc1
L_ple_30:
    s_waitcnt vmcnt(0)
    v_cmp_ne_u32 vcc, s96, v229
    s_nop 1
    s_cbranch_vccz L_pld_29
    s_mov_b64 exec, vcc
    s_sub_u32 s8, s8, 1
    s_cmp_lg_u32 s8, 0
    s_cbranch_scc1 L_pl_28
L_pld_29:
    s_mov_b64 exec, -1
    s_mov_b64 exec, 1
    v_mov_b32 v244, 162852
    v_mov_b32 v245, 1
    ds_add_u32 v244, v245
    s_mov_b64 exec, -1
L_w4_27:
    s_setprio 2
    v_mov_b32 v244, 162852
    s_mov_b32 s8, 3200000
L_lw_31:
    ds_read_b32 v245, v244
    s_waitcnt lgkmcnt(0)
    v_readfirstlane_b32 s9, v245
    s_nop 1
    s_cmp_ge_u32 s9, 1
    s_cbranch_scc1 L_lwd_32
    s_sleep 1
    s_sub_u32 s8, s8, 1
    s_cmp_lg_u32 s8, 0
    s_cbranch_scc1 L_lw_31
L_lwd_32:
    v_mov_b32 v244, 162848
    s_mov_b32 s8, 3200000
L_lw_33:
    ds_read_b32 v245, v244
    s_waitcnt lgkmcnt(0)
    v_readfirstlane_b32 s9, v245
    s_nop 1
    s_cmp_ge_u32 s9, 1
    s_cbranch_scc1 L_lwd_34
    s_sleep 1
    s_sub_u32 s8, s8, 1
    s_cmp_lg_u32 s8, 0
    s_cbranch_scc1 L_lw_33
L_lwd_34:
    buffer_load_dwordx4 v[112:115], v13, s[56:59], s83 offen sc1
    s_mov_b64 exec, s[88:89]
    buffer_load_dwordx4 v[116:119], v14, s[56:59], s83 offen offset:1024 sc1
    buffer_load_dwordx4 v[120:123], v14, s[56:59], s83 offen offset:1536 sc1
    s_mov_b64 exec, -1
    s_add_u32 s83, s83, 4096
    buffer_load_dwordx4 v[124:127], v13, s[56:59], s83 offen sc1
    s_mov_b64 exec, s[88:89]
    buffer_load_dwordx4 v[128:131], v14, s[56:59], s83 offen offset:1024 sc1
    buffer_load_dwordx4 v[132:135], v14, s[56:59], s83 offen offset:1536 sc1
    s_mov_b64 exec, -1
    s_add_u32 s83, s83, 4096
    buffer_load_dwordx4 v[136:139], v13, s[56:59], s83 offen sc1
    s_mov_b64 exec, s[88:89]
    buffer_load_dwordx4 v[140:143], v14, s[56:59], s83 offen offset:1024 sc1
    buffer_load_dwordx4 v[144:147], v14, s[56:59], s83 offen offset:1536 sc1
    s_mov_b64 exec, -1
    s_add_u32 s83, s83, 4096
    s_lshr_b32 s9, s3, 1
    s_add_u32 s8, s9, 1
    s_and_b32 s8, s8, 3
    s_lshl_b32 s8, s8, 10
    s_add_u32 s8, s8, s72
    v_add_u32 v255, s8, v13
    ds_read_b128 v[4:7], v255
    s_add_u32 s8, s9, 2
    s_and_b32 s8, s8, 3
    s_lshl_b32 s8, s8, 10
    s_add_u32 s8, s8, s72
    v_add_u32 v255, s8, v13
    ds_read_b128 v[8:11], v255
    s_add_u32 s8, s9, 3
    s_and_b32 s8, s8, 3
    s_lshl_b32 s8, s8, 10
    s_add_u32 s8, s8, s72
    v_add_u32 v255, s8, v13
    ds_read_b128 v[148:151], v255
    s_add_u32 s8, s9, 4
    s_and_b32 s8, s8, 3
    s_lshl_b32 s8, s8, 10
    s_add_u32 s8, s8, s72
    v_add_u32 v255, s8, v13
    ds_read_b128 v[152:155], v255
    v_lshrrev_b32 v2, 5, v0
    v_mul_u32_u24 v2, 384, v2
    v_add_u32 v2, v2, v235
    s_setprio 3
    s_waitcnt vmcnt(8) lgkmcnt(0)
    v_mfma_f32_32x32x16_bf16 v[16:31], v[112:115], v[4:7], 0
    s_nop 11
    v_exp_f32 v16, v16
    v_exp_f32 v17, v17
    v_exp_f32 v18, v18
    v_exp_f32 v19, v19
    v_exp_f32 v20, v20
    v_mfma_f32_32x32x16_bf16 v[32:47], v[112:115], v[8:11], 0
    v_exp_f32 v21, v21
    v_exp_f32 v22, v22
    v_exp_f32 v23, v23
    v_exp_f32 v24, v24
    v_exp_f32 v25, v25
    s_waitcnt vmcnt(6)
    v_smfmac_f32_32x32x32_bf16 v[48:63], v[116:119], v[16:23], v12
    v_exp_f32 v26, v26
    v_exp_f32 v27, v27
    s_cmp_lg_u32 s80, 0
    s_cbranch_scc1 L_el_35
    ds_write_b128 v246, v[172:175] offset:0
    ds_write_b128 v246, v[176:179] offset:1024
    ds_write_b128 v246, v[180:183] offset:2048
    ds_write_b128 v246, v[184:187] offset:3072
    s_branch L_fi_36
L_el_35:
    ds_write_b128 v246, v[156:159] offset:0
    ds_write_b128 v246, v[160:163] offset:1024
    ds_write_b128 v246, v[164:167] offset:2048
    ds_write_b128 v246, v[168:171] offset:3072
L_fi_36:
    s_mov_b64 exec, 1
    v_mov_b32 v244, s12
    v_mov_b32 v245, 1
    ds_add_u32 v244, v245
    s_mov_b64 exec, -1
    v_exp_f32 v28, v28
    v_exp_f32 v29, v29
    v_exp_f32 v30, v30
    v_exp_f32 v31, v31
    v_exp_f32 v32, v32
    v_exp_f32 v33, v33
    v_smfmac_f32_32x32x32_bf16 v[48:63], v[120:123], v[24:31], v12
    v_exp_f32 v34, v34
    v_exp_f32 v35, v35
    v_exp_f32 v36, v36
    v_mfma_f32_32x32x16_bf16 v[16:31], v[112:115], v[148:151], 0
    v_exp_f32 v37, v37
    v_exp_f32 v38, v38
    v_exp_f32 v39, v39
    v_exp_f32 v40, v40
    v_exp_f32 v41, v41
    v_smfmac_f32_32x32x32_bf16 v[64:79], v[116:119], v[32:39], v12
    v_exp_f32 v42, v42
    v_exp_f32 v43, v43
    v_exp_f32 v44, v44
    v_exp_f32 v45, v45
    v_exp_f32 v46, v46
    v_exp_f32 v47, v47
    v_exp_f32 v16, v16
    v_exp_f32 v17, v17
    v_smfmac_f32_32x32x32_bf16 v[64:79], v[120:123], v[40:47], v12
    v_exp_f32 v18, v18
    v_exp_f32 v19, v19
    v_exp_f32 v20, v20
    v_mfma_f32_32x32x16_bf16 v[32:47], v[112:115], v[152:155], 0
    v_exp_f32 v21, v21
    v_exp_f32 v22, v22
    v_exp_f32 v23, v23
    v_exp_f32 v24, v24
    v_exp_f32 v25, v25
    v_smfmac_f32_32x32x32_bf16 v[80:95], v[116:119], v[16:23], v12
    v_exp_f32 v26, v26
    v_exp_f32 v27, v27
    v_mov_b32 v244, s12
    s_mov_b32 s8, 3200000
L_lw_37:
    ds_read_b32 v245, v244
    s_waitcnt lgkmcnt(0)
    v_readfirstlane_b32 s9, v245
    s_nop 1
    s_cmp_ge_u32 s9, 2
    s_cbranch_scc1 L_lwd_38
    s_sleep 1
    s_sub_u32 s8, s8, 1
    s_cmp_lg_u32 s8, 0
    s_cbranch_scc1 L_lw_37
L_lwd_38:
    ds_read_b128 v[188:191], v247 offset:0
    ds_read_b128 v[192:195], v247 offset:1024
    ds_read_b128 v[196:199], v247 offset:2048
    ds_read_b128 v[200:203], v247 offset:3072
    v_exp_f32 v28, v28
    v_exp_f32 v29, v29
    v_exp_f32 v30, v30
    v_exp_f32 v31, v31
    v_exp_f32 v32, v32
    v_exp_f32 v33, v33
    v_smfmac_f32_32x32x32_bf16 v[80:95], v[120:123], v[24:31], v12
    v_exp_f32 v34, v34
    v_exp_f32 v35, v35
    v_exp_f32 v36, v36
    s_waitcnt vmcnt(3)
    v_mfma_f32_32x32x16_bf16 v[16:31], v[124:127], v[4:7], 0
    v_exp_f32 v37, v37
    v_exp_f32 v38, v38
    v_exp_f32 v39, v39
    v_exp_f32 v40, v40
    v_exp_f32 v41, v41
    v_smfmac_f32_32x32x32_bf16 v[96:111], v[116:119], v[32:39], v12
    v_exp_f32 v42, v42
    v_exp_f32 v43, v43
    s_waitcnt lgkmcnt(0)
    s_cmp_lg_u32 s80, 0
    s_cbranch_scc1 L_el_39
    v_add_f32 v156, v156, v188
    v_add_f32 v157, v157, v189
    v_add_f32 v158, v158, v190
    v_add_f32 v159, v159, v191
    v_add_f32 v160, v160, v192
    v_add_f32 v161, v161, v193
    v_add_f32 v162, v162, v194
    v_add_f32 v163, v163, v195
    v_add_f32 v164, v164, v196
    v_add_f32 v165, v165, v197
    v_add_f32 v166, v166, v198
    v_add_f32 v167, v167, v199
    v_add_f32 v168, v168, v200
    v_add_f32 v169, v169, v201
    v_add_f32 v170, v170, v202
    v_add_f32 v171, v171, v203
    v_cvt_pk_bf16_f32 v204, v156, v157
    v_cvt_pk_bf16_f32 v205, v158, v159
    v_cvt_pk_bf16_f32 v206, v160, v161
    v_cvt_pk_bf16_f32 v207, v162, v163
    v_cvt_pk_bf16_f32 v208, v164, v165
    v_cvt_pk_bf16_f32 v209, v166, v167
    v_cvt_pk_bf16_f32 v210, v168, v169
    v_cvt_pk_bf16_f32 v211, v170, v171
    s_branch L_fi_40
L_el_39:
    v_add_f32 v172, v172, v188
    v_add_f32 v173, v173, v189
    v_add_f32 v174, v174, v190
    v_add_f32 v175, v175, v191
    v_add_f32 v176, v176, v192
    v_add_f32 v177, v177, v193
    v_add_f32 v178, v178, v194
    v_add_f32 v179, v179, v195
    v_add_f32 v180, v180, v196
    v_add_f32 v181, v181, v197
    v_add_f32 v182, v182, v198
    v_add_f32 v183, v183, v199
    v_add_f32 v184, v184, v200
    v_add_f32 v185, v185, v201
    v_add_f32 v186, v186, v202
    v_add_f32 v187, v187, v203
    v_cvt_pk_bf16_f32 v204, v172, v173
    v_cvt_pk_bf16_f32 v205, v174, v175
    v_cvt_pk_bf16_f32 v206, v176, v177
    v_cvt_pk_bf16_f32 v207, v178, v179
    v_cvt_pk_bf16_f32 v208, v180, v181
    v_cvt_pk_bf16_f32 v209, v182, v183
    v_cvt_pk_bf16_f32 v210, v184, v185
    v_cvt_pk_bf16_f32 v211, v186, v187
L_fi_40:
    v_permlane16_swap_b32 v204, v206
    v_permlane16_swap_b32 v205, v207
    v_permlane16_swap_b32 v208, v210
    v_permlane16_swap_b32 v209, v211
    buffer_store_dwordx4 v[204:207], v248, s[56:59], s100 offen sc1
    buffer_store_dwordx4 v[208:211], v248, s[56:59], s100 offen offset:1024 sc1
    v_exp_f32 v44, v44
    v_exp_f32 v45, v45
    v_exp_f32 v46, v46
    v_exp_f32 v47, v47
    s_branch L_merge
L_attn:
    s_setprio 2
    s_waitcnt vmcnt(8) lgkmcnt(0)
    v_mfma_f32_32x32x16_bf16 v[16:31], v[112:115], v[4:7], 0
    s_nop 11
    v_exp_f32 v16, v16
    v_exp_f32 v17, v17
    v_exp_f32 v18, v18
    v_exp_f32 v19, v19
    v_exp_f32 v20, v20
    v_mfma_f32_32x32x16_bf16 v[32:47], v[112:115], v[8:11], 0
    v_exp_f32 v21, v21
    v_exp_f32 v22, v22
    v_exp_f32 v23, v23
    v_exp_f32 v24, v24
    v_exp_f32 v25, v25
    s_waitcnt vmcnt(6)
    v_smfmac_f32_32x32x32_bf16 v[48:63], v[116:119], v[16:23], v12
    v_exp_f32 v26, v26
    v_exp_f32 v27, v27
    v_exp_f32 v28, v28
    v_exp_f32 v29, v29
    v_exp_f32 v30, v30
    v_exp_f32 v31, v31
    v_exp_f32 v32, v32
    v_exp_f32 v33, v33
    v_smfmac_f32_32x32x32_bf16 v[48:63], v[120:123], v[24:31], v12
    v_exp_f32 v34, v34
    v_exp_f32 v35, v35
    v_exp_f32 v36, v36
    v_mfma_f32_32x32x16_bf16 v[16:31], v[112:115], v[148:151], 0
    v_exp_f32 v37, v37
    v_exp_f32 v38, v38
    v_exp_f32 v39, v39
    v_exp_f32 v40, v40
    v_exp_f32 v41, v41
    v_smfmac_f32_32x32x32_bf16 v[64:79], v[116:119], v[32:39], v12
    v_exp_f32 v42, v42
    v_exp_f32 v43, v43
    v_exp_f32 v44, v44
    v_exp_f32 v45, v45
    v_exp_f32 v46, v46
    v_exp_f32 v47, v47
    v_exp_f32 v16, v16
    v_exp_f32 v17, v17
    v_smfmac_f32_32x32x32_bf16 v[64:79], v[120:123], v[40:47], v12
    v_exp_f32 v18, v18
    v_exp_f32 v19, v19
    v_exp_f32 v20, v20
    v_mfma_f32_32x32x16_bf16 v[32:47], v[112:115], v[152:155], 0
    v_exp_f32 v21, v21
    v_exp_f32 v22, v22
    v_exp_f32 v23, v23
    v_exp_f32 v24, v24
    v_exp_f32 v25, v25
    v_smfmac_f32_32x32x32_bf16 v[80:95], v[116:119], v[16:23], v12
    v_exp_f32 v26, v26
    v_exp_f32 v27, v27
    v_exp_f32 v28, v28
    v_exp_f32 v29, v29
    v_exp_f32 v30, v30
    v_exp_f32 v31, v31
    v_exp_f32 v32, v32
    v_exp_f32 v33, v33
    v_smfmac_f32_32x32x32_bf16 v[80:95], v[120:123], v[24:31], v12
    v_exp_f32 v34, v34
    v_exp_f32 v35, v35
    v_exp_f32 v36, v36
    s_waitcnt vmcnt(3)
    v_mfma_f32_32x32x16_bf16 v[16:31], v[124:127], v[4:7], 0
    v_exp_f32 v37, v37
    v_exp_f32 v38, v38
    v_exp_f32 v39, v39
    v_exp_f32 v40, v40
    v_exp_f32 v41, v41
    v_smfmac_f32_32x32x32_bf16 v[96:111], v[116:119], v[32:39], v12
    v_exp_f32 v42, v42
    v_exp_f32 v43, v43
    v_exp_f32 v44, v44
    v_exp_f32 v45, v45
    v_exp_f32 v46, v46
    v_exp_f32 v47, v47
L_merge:
    v_exp_f32 v16, v16
    v_exp_f32 v17, v17
    v_smfmac_f32_32x32x32_bf16 v[96:111], v[120:123], v[40:47], v12
    v_exp_f32 v18, v18
    buffer_load_dwordx4 v[112:115], v13, s[56:59], s83 offen sc1
    v_exp_f32 v19, v19
    s_mov_b64 exec, s[88:89]
    buffer_load_dwordx4 v[116:119], v14, s[56:59], s83 offen offset:1024 sc1
    buffer_load_dwordx4 v[120:123], v14, s[56:59], s83 offen offset:1536 sc1
    s_mov_b64 exec, -1
    s_add_u32 s83, s83, 4096
    s_and_b32 s83, s83, 0x1ffff
    s_or_b32 s83, s83, s84
    v_exp_f32 v20, v20
    v_mfma_f32_32x32x16_bf16 v[32:47], v[124:127], v[8:11], 0
    v_exp_f32 v21, v21
    v_exp_f32 v22, v22
    v_exp_f32 v23, v23
    v_exp_f32 v24, v24
    v_exp_f32 v25, v25
    v_smfmac_f32_32x32x32_bf16 v[48:63], v[128:131], v[16:23], v12
    v_exp_f32 v26, v26
    v_exp_f32 v27, v27
    v_exp_f32 v28, v28
    v_exp_f32 v29, v29
    v_exp_f32 v30, v30
    v_exp_f32 v31, v31
    v_exp_f32 v32, v32
    v_exp_f32 v33, v33
    v_smfmac_f32_32x32x32_bf16 v[48:63], v[132:135], v[24:31], v12
    v_exp_f32 v34, v34
    v_exp_f32 v35, v35
    v_exp_f32 v36, v36
    v_mfma_f32_32x32x16_bf16 v[16:31], v[124:127], v[148:151], 0
    v_exp_f32 v37, v37
    v_exp_f32 v38, v38
    v_exp_f32 v39, v39
    v_exp_f32 v40, v40
    v_exp_f32 v41, v41
    v_smfmac_f32_32x32x32_bf16 v[64:79], v[128:131], v[32:39], v12
    v_exp_f32 v42, v42
    v_exp_f32 v43, v43
    v_exp_f32 v44, v44
    v_exp_f32 v45, v45
    v_exp_f32 v46, v46
    v_exp_f32 v47, v47
    v_exp_f32 v16, v16
    v_exp_f32 v17, v17
    v_smfmac_f32_32x32x32_bf16 v[64:79], v[132:135], v[40:47], v12
    v_exp_f32 v18, v18
    v_exp_f32 v19, v19
    v_exp_f32 v20, v20
    v_mfma_f32_32x32x16_bf16 v[32:47], v[124:127], v[152:155], 0
    v_exp_f32 v21, v21
    v_exp_f32 v22, v22
    v_exp_f32 v23, v23
    v_exp_f32 v24, v24
    v_exp_f32 v25, v25
    v_smfmac_f32_32x32x32_bf16 v[80:95], v[128:131], v[16:23], v12
    v_exp_f32 v26, v26
    v_exp_f32 v27, v27
    v_exp_f32 v28, v28
    v_exp_f32 v29, v29
    v_exp_f32 v30, v30
    v_exp_f32 v31, v31
    v_exp_f32 v32, v32
    v_exp_f32 v33, v33
    v_smfmac_f32_32x32x32_bf16 v[80:95], v[132:135], v[24:31], v12
    v_exp_f32 v34, v34
    v_exp_f32 v35, v35
    v_exp_f32 v36, v36
    s_waitcnt vmcnt(3)
    v_mfma_f32_32x32x16_bf16 v[16:31], v[136:139], v[4:7], 0
    v_exp_f32 v37, v37
    v_exp_f32 v38, v38
    v_exp_f32 v39, v39
    v_exp_f32 v40, v40
    v_exp_f32 v41, v41
    v_smfmac_f32_32x32x32_bf16 v[96:111], v[128:131], v[32:39], v12
    v_exp_f32 v42, v42
    v_exp_f32 v43, v43
    v_exp_f32 v44, v44
    v_exp_f32 v45, v45
    v_exp_f32 v46, v46
    v_exp_f32 v47, v47
    s_cmp_lg_u32 s82, 0
    s_cbranch_scc1 L_nok2_41
    v_mov_b32 v244, 162852
    s_mov_b32 s8, 3200000
L_lw_42:
    ds_read_b32 v245, v244
    s_waitcnt lgkmcnt(0)
    v_readfirstlane_b32 s9, v245
    s_nop 1
    s_cmp_ge_u32 s9, 1
    s_cbranch_scc1 L_lwd_43
    s_sleep 1
    s_sub_u32 s8, s8, 1
    s_cmp_lg_u32 s8, 0
    s_cbranch_scc1 L_lw_42
L_lwd_43:
L_nok2_41:
    v_exp_f32 v16, v16
    v_exp_f32 v17, v17
    v_smfmac_f32_32x32x32_bf16 v[96:111], v[132:135], v[40:47], v12
    v_exp_f32 v18, v18
    buffer_load_dwordx4 v[124:127], v13, s[56:59], s83 offen sc1
    v_exp_f32 v19, v19
    s_mov_b64 exec, s[88:89]
    buffer_load_dwordx4 v[128:131], v14, s[56:59], s83 offen offset:1024 sc1
    buffer_load_dwordx4 v[132:135], v14, s[56:59], s83 offen offset:1536 sc1
    s_mov_b64 exec, -1
    s_add_u32 s83, s83, 4096
    v_exp_f32 v20, v20
    v_mfma_f32_32x32x16_bf16 v[32:47], v[136:139], v[8:11], 0
    v_exp_f32 v21, v21
    v_exp_f32 v22, v22
    v_exp_f32 v23, v23
    v_exp_f32 v24, v24
    v_exp_f32 v25, v25
    v_smfmac_f32_32x32x32_bf16 v[48:63], v[140:143], v[16:23], v12
    v_exp_f32 v26, v26
    v_exp_f32 v27, v27
    v_exp_f32 v28, v28
    v_exp_f32 v29, v29
    v_exp_f32 v30, v30
    v_exp_f32 v31, v31
    v_exp_f32 v32, v32
    v_exp_f32 v33, v33
    v_smfmac_f32_32x32x32_bf16 v[48:63], v[144:147], v[24:31], v12
    v_exp_f32 v34, v34
    v_exp_f32 v35, v35
    v_exp_f32 v36, v36
    v_mfma_f32_32x32x16_bf16 v[16:31], v[136:139], v[148:151], 0
    v_exp_f32 v37, v37
    v_exp_f32 v38, v38
    v_exp_f32 v39, v39
    v_exp_f32 v40, v40
    v_exp_f32 v41, v41
    v_smfmac_f32_32x32x32_bf16 v[64:79], v[140:143], v[32:39], v12
    v_exp_f32 v42, v42
    v_exp_f32 v43, v43
    v_exp_f32 v44, v44
    v_exp_f32 v45, v45
    v_exp_f32 v46, v46
    v_exp_f32 v47, v47
    v_exp_f32 v16, v16
    v_exp_f32 v17, v17
    v_smfmac_f32_32x32x32_bf16 v[64:79], v[144:147], v[40:47], v12
    v_exp_f32 v18, v18
    v_exp_f32 v19, v19
    v_exp_f32 v20, v20
    v_mfma_f32_32x32x16_bf16 v[32:47], v[136:139], v[152:155], 0
    v_exp_f32 v21, v21
    v_exp_f32 v22, v22
    v_exp_f32 v23, v23
    v_exp_f32 v24, v24
    v_exp_f32 v25, v25
    v_smfmac_f32_32x32x32_bf16 v[80:95], v[140:143], v[16:23], v12
    v_exp_f32 v26, v26
    v_exp_f32 v27, v27
    v_exp_f32 v28, v28
    v_exp_f32 v29, v29
    v_exp_f32 v30, v30
    v_exp_f32 v31, v31
    v_exp_f32 v32, v32
    v_exp_f32 v33, v33
    v_smfmac_f32_32x32x32_bf16 v[80:95], v[144:147], v[24:31], v12
    v_exp_f32 v34, v34
    v_exp_f32 v35, v35
    v_exp_f32 v36, v36
    s_waitcnt vmcnt(3)
    v_mfma_f32_32x32x16_bf16 v[16:31], v[112:115], v[4:7], 0
    v_exp_f32 v37, v37
    v_exp_f32 v38, v38
    v_exp_f32 v39, v39
    v_exp_f32 v40, v40
    v_exp_f32 v41, v41
    v_smfmac_f32_32x32x32_bf16 v[96:111], v[140:143], v[32:39], v12
    v_exp_f32 v42, v42
    v_exp_f32 v43, v43
    v_exp_f32 v44, v44
    v_exp_f32 v45, v45
    v_exp_f32 v46, v46
    v_exp_f32 v47, v47
    s_cmp_eq_u32 s82, 0
    s_cbranch_scc1 L_nof3_44
    s_mov_b64 exec, 1
    v_mov_b32 v1, s96
    buffer_store_dword v1, off, s[56:59], s91 sc1
    s_mov_b64 exec, -1
L_nof3_44:
    v_exp_f32 v16, v16
    v_exp_f32 v17, v17
    v_smfmac_f32_32x32x32_bf16 v[96:111], v[144:147], v[40:47], v12
    v_exp_f32 v18, v18
    buffer_load_dwordx4 v[136:139], v13, s[56:59], s83 offen sc1
    v_exp_f32 v19, v19
    s_mov_b64 exec, s[88:89]
    buffer_load_dwordx4 v[140:143], v14, s[56:59], s83 offen offset:1024 sc1
    buffer_load_dwordx4 v[144:147], v14, s[56:59], s83 offen offset:1536 sc1
    s_mov_b64 exec, -1
    s_add_u32 s83, s83, 4096
    v_exp_f32 v20, v20
    v_mfma_f32_32x32x16_bf16 v[32:47], v[112:115], v[8:11], 0
    v_exp_f32 v21, v21
    v_exp_f32 v22, v22
    v_exp_f32 v23, v23
    v_exp_f32 v24, v24
    v_exp_f32 v25, v25
    v_smfmac_f32_32x32x32_bf16 v[48:63], v[116:119], v[16:23], v12
    v_exp_f32 v26, v26
    v_exp_f32 v27, v27
    v_exp_f32 v28, v28
    v_exp_f32 v29, v29
    v_exp_f32 v30, v30
    v_exp_f32 v31, v31
    v_exp_f32 v32, v32
    v_exp_f32 v33, v33
    v_smfmac_f32_32x32x32_bf16 v[48:63], v[120:123], v[24:31], v12
    v_exp_f32 v34, v34
    v_exp_f32 v35, v35
    v_exp_f32 v36, v36
    v_mfma_f32_32x32x16_bf16 v[16:31], v[112:115], v[148:151], 0
    v_exp_f32 v37, v37
    v_exp_f32 v38, v38
    v_exp_f32 v39, v39
    v_exp_f32 v40, v40
    v_exp_f32 v41, v41
    v_smfmac_f32_32x32x32_bf16 v[64:79], v[116:119], v[32:39], v12
    v_exp_f32 v42, v42
    v_exp_f32 v43, v43
    v_exp_f32 v44, v44
    v_exp_f32 v45, v45
    v_exp_f32 v46, v46
    v_exp_f32 v47, v47
    v_exp_f32 v16, v16
    v_exp_f32 v17, v17
    v_smfmac_f32_32x32x32_bf16 v[64:79], v[120:123], v[40:47], v12
    v_exp_f32 v18, v18
    v_exp_f32 v19, v19
    v_exp_f32 v20, v20
    v_mfma_f32_32x32x16_bf16 v[32:47], v[112:115], v[152:155], 0
    v_exp_f32 v21, v21
    v_exp_f32 v22, v22
    v_exp_f32 v23, v23
    v_exp_f32 v24, v24
    v_exp_f32 v25, v25
    v_smfmac_f32_32x32x32_bf16 v[80:95], v[116:119], v[16:23], v12
    v_exp_f32 v26, v26
    v_exp_f32 v27, v27
    v_exp_f32 v28, v28
    v_exp_f32 v29, v29
    v_exp_f32 v30, v30
    v_exp_f32 v31, v31
    v_exp_f32 v32, v32
    v_exp_f32 v33, v33
    v_smfmac_f32_32x32x32_bf16 v[80:95], v[120:123], v[24:31], v12
    v_exp_f32 v34, v34
    v_exp_f32 v35, v35
    v_exp_f32 v36, v36
    s_waitcnt vmcnt(3)
    v_mfma_f32_32x32x16_bf16 v[16:31], v[124:127], v[4:7], 0
    v_exp_f32 v37, v37
    v_exp_f32 v38, v38
    v_exp_f32 v39, v39
    v_exp_f32 v40, v40
    v_exp_f32 v41, v41
    v_smfmac_f32_32x32x32_bf16 v[96:111], v[116:119], v[32:39], v12
    v_exp_f32 v42, v42
    v_exp_f32 v43, v43
    v_exp_f32 v44, v44
    v_exp_f32 v45, v45
    v_exp_f32 v46, v46
    v_exp_f32 v47, v47
    v_exp_f32 v16, v16
    v_exp_f32 v17, v17
    v_smfmac_f32_32x32x32_bf16 v[96:111], v[120:123], v[40:47], v12
    v_exp_f32 v18, v18
    buffer_load_dwordx4 v[112:115], v13, s[56:59], s83 offen sc1
    v_exp_f32 v19, v19
    s_mov_b64 exec, s[88:89]
    buffer_load_dwordx4 v[116:119], v14, s[56:59], s83 offen offset:1024 sc1
    buffer_load_dwordx4 v[120:123], v14, s[56:59], s83 offen offset:1536 sc1
    s_mov_b64 exec, -1
    s_add_u32 s83, s83, 4096
    v_exp_f32 v20, v20
    v_mfma_f32_32x32x16_bf16 v[32:47], v[124:127], v[8:11], 0
    v_exp_f32 v21, v21
    v_exp_f32 v22, v22
    v_exp_f32 v23, v23
    v_exp_f32 v24, v24
    v_exp_f32 v25, v25
    v_smfmac_f32_32x32x32_bf16 v[48:63], v[128:131], v[16:23], v12
    v_exp_f32 v26, v26
    v_exp_f32 v27, v27
    v_exp_f32 v28, v28
    v_exp_f32 v29, v29
    v_exp_f32 v30, v30
    v_exp_f32 v31, v31
    v_exp_f32 v32, v32
    v_exp_f32 v33, v33
    v_smfmac_f32_32x32x32_bf16 v[48:63], v[132:135], v[24:31], v12
    v_exp_f32 v34, v34
    v_exp_f32 v35, v35
    v_exp_f32 v36, v36
    v_mfma_f32_32x32x16_bf16 v[16:31], v[124:127], v[148:151], 0
    v_exp_f32 v37, v37
    v_exp_f32 v38, v38
    v_exp_f32 v39, v39
    v_exp_f32 v40, v40
    v_exp_f32 v41, v41
    v_smfmac_f32_32x32x32_bf16 v[64:79], v[128:131], v[32:39], v12
    v_exp_f32 v42, v42
    v_exp_f32 v43, v43
    v_exp_f32 v44, v44
    v_exp_f32 v45, v45
    v_exp_f32 v46, v46
    v_exp_f32 v47, v47
    v_exp_f32 v16, v16
    v_exp_f32 v17, v17
    v_smfmac_f32_32x32x32_bf16 v[64:79], v[132:135], v[40:47], v12
    v_exp_f32 v18, v18
    v_exp_f32 v19, v19
    v_exp_f32 v20, v20
    v_mfma_f32_32x32x16_bf16 v[32:47], v[124:127], v[152:155], 0
    v_exp_f32 v21, v21
    v_exp_f32 v22, v22
    v_exp_f32 v23, v23
    v_exp_f32 v24, v24
    v_exp_f32 v25, v25
    v_smfmac_f32_32x32x32_bf16 v[80:95], v[128:131], v[16:23], v12
    v_exp_f32 v26, v26
    v_exp_f32 v27, v27
    v_exp_f32 v28, v28
    v_exp_f32 v29, v29
    v_exp_f32 v30, v30
    v_exp_f32 v31, v31
    v_exp_f32 v32, v32
    v_exp_f32 v33, v33
    v_smfmac_f32_32x32x32_bf16 v[80:95], v[132:135], v[24:31], v12
    v_exp_f32 v34, v34
    v_exp_f32 v35, v35
    v_exp_f32 v36, v36
    s_waitcnt vmcnt(3)
    v_mfma_f32_32x32x16_bf16 v[16:31], v[136:139], v[4:7], 0
    v_exp_f32 v37, v37
    v_exp_f32 v38, v38
    v_exp_f32 v39, v39
    v_exp_f32 v40, v40
    v_exp_f32 v41, v41
    v_smfmac_f32_32x32x32_bf16 v[96:111], v[128:131], v[32:39], v12
    v_exp_f32 v42, v42
    v_exp_f32 v43, v43
    v_exp_f32 v44, v44
    v_exp_f32 v45, v45
    v_exp_f32 v46, v46
    v_exp_f32 v47, v47
    v_exp_f32 v16, v16
    v_exp_f32 v17, v17
    v_smfmac_f32_32x32x32_bf16 v[96:111], v[132:135], v[40:47], v12
    v_exp_f32 v18, v18
    buffer_load_dwordx4 v[124:127], v13, s[56:59], s83 offen sc1
    v_exp_f32 v19, v19
    s_mov_b64 exec, s[88:89]
    buffer_load_dwordx4 v[128:131], v14, s[56:59], s83 offen offset:1024 sc1
    buffer_load_dwordx4 v[132:135], v14, s[56:59], s83 offen offset:1536 sc1
    s_mov_b64 exec, -1
    s_add_u32 s83, s83, 4096
    s_and_b32 s83, s83, 0x1ffff
    s_or_b32 s83, s83, s84
    v_exp_f32 v20, v20
    v_mfma_f32_32x32x16_bf16 v[32:47], v[136:139], v[8:11], 0
    v_exp_f32 v21, v21
    v_exp_f32 v22, v22
    v_exp_f32 v23, v23
    v_exp_f32 v24, v24
    v_exp_f32 v25, v25
    v_smfmac_f32_32x32x32_bf16 v[48:63], v[140:143], v[16:23], v12
    v_exp_f32 v26, v26
    v_exp_f32 v27, v27
    v_exp_f32 v28, v28
    v_exp_f32 v29, v29
    v_exp_f32 v30, v30
    v_exp_f32 v31, v31
    v_exp_f32 v32, v32
    v_exp_f32 v33, v33
    v_smfmac_f32_32x32x32_bf16 v[48:63], v[144:147], v[24:31], v12
    v_exp_f32 v34, v34
    v_exp_f32 v35, v35
    v_exp_f32 v36, v36
    v_mfma_f32_32x32x16_bf16 v[16:31], v[136:139], v[148:151], 0
    v_exp_f32 v37, v37
    v_exp_f32 v38, v38
    v_exp_f32 v39, v39
    v_exp_f32 v40, v40
    v_exp_f32 v41, v41
    v_smfmac_f32_32x32x32_bf16 v[64:79], v[140:143], v[32:39], v12
    v_exp_f32 v42, v42
    v_exp_f32 v43, v43
    v_exp_f32 v44, v44
    v_exp_f32 v45, v45
    v_exp_f32 v46, v46
    v_exp_f32 v47, v47
    v_exp_f32 v16, v16
    v_exp_f32 v17, v17
    v_smfmac_f32_32x32x32_bf16 v[64:79], v[144:147], v[40:47], v12
    v_exp_f32 v18, v18
    v_exp_f32 v19, v19
    v_exp_f32 v20, v20
    v_mfma_f32_32x32x16_bf16 v[32:47], v[136:139], v[152:155], 0
    v_exp_f32 v21, v21
    v_exp_f32 v22, v22
    v_exp_f32 v23, v23
    v_exp_f32 v24, v24
    v_exp_f32 v25, v25
    v_smfmac_f32_32x32x32_bf16 v[80:95], v[140:143], v[16:23], v12
    v_exp_f32 v26, v26
    v_exp_f32 v27, v27
    v_exp_f32 v28, v28
    v_exp_f32 v29, v29
    v_exp_f32 v30, v30
    v_exp_f32 v31, v31
    v_exp_f32 v32, v32
    v_exp_f32 v33, v33
    v_smfmac_f32_32x32x32_bf16 v[80:95], v[144:147], v[24:31], v12
    v_exp_f32 v34, v34
    v_exp_f32 v35, v35
    v_exp_f32 v36, v36
    s_waitcnt vmcnt(3)
    v_mfma_f32_32x32x16_bf16 v[16:31], v[112:115], v[4:7], 0
    v_exp_f32 v37, v37
    v_exp_f32 v38, v38
    v_exp_f32 v39, v39
    v_exp_f32 v40, v40
    v_exp_f32 v41, v41
    v_smfmac_f32_32x32x32_bf16 v[96:111], v[140:143], v[32:39], v12
    v_exp_f32 v42, v42
    v_exp_f32 v43, v43
    v_exp_f32 v44, v44
    v_exp_f32 v45, v45
    v_exp_f32 v46, v46
    v_exp_f32 v47, v47
    v_exp_f32 v16, v16
    v_exp_f32 v17, v17
    v_smfmac_f32_32x32x32_bf16 v[96:111], v[144:147], v[40:47], v12
    v_exp_f32 v18, v18
    buffer_load_dwordx4 v[136:139], v13, s[56:59], s83 offen sc1
    v_exp_f32 v19, v19
    s_mov_b64 exec, s[88:89]
    buffer_load_dwordx4 v[140:143], v14, s[56:59], s83 offen offset:1024 sc1
    buffer_load_dwordx4 v[144:147], v14, s[56:59], s83 offen offset:1536 sc1
    s_mov_b64 exec, -1
    s_add_u32 s83, s83, 4096
    v_exp_f32 v20, v20
    v_mfma_f32_32x32x16_bf16 v[32:47], v[112:115], v[8:11], 0
    v_exp_f32 v21, v21
    v_exp_f32 v22, v22
    v_exp_f32 v23, v23
    v_exp_f32 v24, v24
    v_exp_f32 v25, v25
    v_smfmac_f32_32x32x32_bf16 v[48:63], v[116:119], v[16:23], v12
    v_exp_f32 v26, v26
    v_exp_f32 v27, v27
    v_exp_f32 v28, v28
    v_exp_f32 v29, v29
    v_exp_f32 v30, v30
    v_exp_f32 v31, v31
    v_exp_f32 v32, v32
    v_exp_f32 v33, v33
    v_smfmac_f32_32x32x32_bf16 v[48:63], v[120:123], v[24:31], v12
    v_exp_f32 v34, v34
    v_exp_f32 v35, v35
    v_exp_f32 v36, v36
    v_mfma_f32_32x32x16_bf16 v[16:31], v[112:115], v[148:151], 0
    v_exp_f32 v37, v37
    v_exp_f32 v38, v38
    v_exp_f32 v39, v39
    v_exp_f32 v40, v40
    v_exp_f32 v41, v41
    v_smfmac_f32_32x32x32_bf16 v[64:79], v[116:119], v[32:39], v12
    v_exp_f32 v42, v42
    v_exp_f32 v43, v43
    v_exp_f32 v44, v44
    v_exp_f32 v45, v45
    v_exp_f32 v46, v46
    v_exp_f32 v47, v47
    v_exp_f32 v16, v16
    v_exp_f32 v17, v17
    v_smfmac_f32_32x32x32_bf16 v[64:79], v[120:123], v[40:47], v12
    v_exp_f32 v18, v18
    v_exp_f32 v19, v19
    v_exp_f32 v20, v20
    v_mfma_f32_32x32x16_bf16 v[32:47], v[112:115], v[152:155], 0
    v_exp_f32 v21, v21
    v_exp_f32 v22, v22
    v_exp_f32 v23, v23
    v_exp_f32 v24, v24
    v_exp_f32 v25, v25
    v_smfmac_f32_32x32x32_bf16 v[80:95], v[116:119], v[16:23], v12
    v_exp_f32 v26, v26
    v_exp_f32 v27, v27
    v_exp_f32 v28, v28
    v_exp_f32 v29, v29
    v_exp_f32 v30, v30
    v_exp_f32 v31, v31
    v_exp_f32 v32, v32
    v_exp_f32 v33, v33
    v_smfmac_f32_32x32x32_bf16 v[80:95], v[120:123], v[24:31], v12
    v_exp_f32 v34, v34
    v_exp_f32 v35, v35
    v_exp_f32 v36, v36
    s_waitcnt vmcnt(3)
    v_mfma_f32_32x32x16_bf16 v[16:31], v[124:127], v[4:7], 0
    v_exp_f32 v37, v37
    v_exp_f32 v38, v38
    v_exp_f32 v39, v39
    v_exp_f32 v40, v40
    v_exp_f32 v41, v41
    v_smfmac_f32_32x32x32_bf16 v[96:111], v[116:119], v[32:39], v12
    v_exp_f32 v42, v42
    v_exp_f32 v43, v43
    v_exp_f32 v44, v44
    v_exp_f32 v45, v45
    v_exp_f32 v46, v46
    v_exp_f32 v47, v47
    v_exp_f32 v16, v16
    v_exp_f32 v17, v17
    v_smfmac_f32_32x32x32_bf16 v[96:111], v[120:123], v[40:47], v12
    v_exp_f32 v18, v18
    buffer_load_dwordx4 v[112:115], v13, s[56:59], s83 offen sc1
    v_exp_f32 v19, v19
    s_mov_b64 exec, s[88:89]
    buffer_load_dwordx4 v[116:119], v14, s[56:59], s83 offen offset:1024 sc1
    buffer_load_dwordx4 v[120:123], v14, s[56:59], s83 offen offset:1536 sc1
    s_mov_b64 exec, -1
    s_add_u32 s83, s83, 4096
    v_exp_f32 v20, v20
    v_mfma_f32_32x32x16_bf16 v[32:47], v[124:127], v[8:11], 0
    v_exp_f32 v21, v21
    v_exp_f32 v22, v22
    v_exp_f32 v23, v23
    v_exp_f32 v24, v24
    v_exp_f32 v25, v25
    v_smfmac_f32_32x32x32_bf16 v[48:63], v[128:131], v[16:23], v12
    v_exp_f32 v26, v26
    v_exp_f32 v27, v27
    v_exp_f32 v28, v28
    v_exp_f32 v29, v29
    v_exp_f32 v30, v30
    v_exp_f32 v31, v31
    v_exp_f32 v32, v32
    v_exp_f32 v33, v33
    v_smfmac_f32_32x32x32_bf16 v[48:63], v[132:135], v[24:31], v12
    v_exp_f32 v34, v34
    v_exp_f32 v35, v35
    v_exp_f32 v36, v36
    v_mfma_f32_32x32x16_bf16 v[16:31], v[124:127], v[148:151], 0
    v_exp_f32 v37, v37
    v_exp_f32 v38, v38
    v_exp_f32 v39, v39
    v_exp_f32 v40, v40
    v_exp_f32 v41, v41
    v_smfmac_f32_32x32x32_bf16 v[64:79], v[128:131], v[32:39], v12
    v_exp_f32 v42, v42
    v_exp_f32 v43, v43
    v_exp_f32 v44, v44
    v_exp_f32 v45, v45
    v_exp_f32 v46, v46
    v_exp_f32 v47, v47
    v_exp_f32 v16, v16
    v_exp_f32 v17, v17
    v_smfmac_f32_32x32x32_bf16 v[64:79], v[132:135], v[40:47], v12
    v_exp_f32 v18, v18
    v_exp_f32 v19, v19
    v_exp_f32 v20, v20
    v_mfma_f32_32x32x16_bf16 v[32:47], v[124:127], v[152:155], 0
    v_exp_f32 v21, v21
    v_exp_f32 v22, v22
    v_exp_f32 v23, v23
    v_exp_f32 v24, v24
    v_exp_f32 v25, v25
    v_smfmac_f32_32x32x32_bf16 v[80:95], v[128:131], v[16:23], v12
    v_exp_f32 v26, v26
    v_exp_f32 v27, v27
    v_exp_f32 v28, v28
    v_exp_f32 v29, v29
    v_exp_f32 v30, v30
    v_exp_f32 v31, v31
    v_exp_f32 v32, v32
    v_exp_f32 v33, v33
    v_smfmac_f32_32x32x32_bf16 v[80:95], v[132:135], v[24:31], v12
    v_exp_f32 v34, v34
    v_exp_f32 v35, v35
    v_exp_f32 v36, v36
    s_waitcnt vmcnt(3)
    v_mfma_f32_32x32x16_bf16 v[16:31], v[136:139], v[4:7], 0
    v_exp_f32 v37, v37
    v_exp_f32 v38, v38
    v_exp_f32 v39, v39
    v_exp_f32 v40, v40
    v_exp_f32 v41, v41
    v_smfmac_f32_32x32x32_bf16 v[96:111], v[128:131], v[32:39], v12
    v_exp_f32 v42, v42
    v_exp_f32 v43, v43
    v_exp_f32 v44, v44
    v_exp_f32 v45, v45
    v_exp_f32 v46, v46
    v_exp_f32 v47, v47
    v_exp_f32 v16, v16
    v_exp_f32 v17, v17
    v_smfmac_f32_32x32x32_bf16 v[96:111], v[132:135], v[40:47], v12
    v_exp_f32 v18, v18
    buffer_load_dwordx4 v[124:127], v13, s[56:59], s83 offen sc1
    v_exp_f32 v19, v19
    s_mov_b64 exec, s[88:89]
    buffer_load_dwordx4 v[128:131], v14, s[56:59], s83 offen offset:1024 sc1
    buffer_load_dwordx4 v[132:135], v14, s[56:59], s83 offen offset:1536 sc1
    s_mov_b64 exec, -1
    s_add_u32 s83, s83, 4096
    v_exp_f32 v20, v20
    v_mfma_f32_32x32x16_bf16 v[32:47], v[136:139], v[8:11], 0
    v_exp_f32 v21, v21
    v_exp_f32 v22, v22
    v_exp_f32 v23, v23
    v_exp_f32 v24, v24
    v_exp_f32 v25, v25
    v_smfmac_f32_32x32x32_bf16 v[48:63], v[140:143], v[16:23], v12
    v_exp_f32 v26, v26
    v_exp_f32 v27, v27
    v_exp_f32 v28, v28
    v_exp_f32 v29, v29
    v_exp_f32 v30, v30
    v_exp_f32 v31, v31
    v_exp_f32 v32, v32
    v_exp_f32 v33, v33
    v_smfmac_f32_32x32x32_bf16 v[48:63], v[144:147], v[24:31], v12
    v_exp_f32 v34, v34
    v_exp_f32 v35, v35
    v_exp_f32 v36, v36
    v_mfma_f32_32x32x16_bf16 v[16:31], v[136:139], v[148:151], 0
    v_exp_f32 v37, v37
    v_exp_f32 v38, v38
    v_exp_f32 v39, v39
    v_exp_f32 v40, v40
    v_exp_f32 v41, v41
    v_smfmac_f32_32x32x32_bf16 v[64:79], v[140:143], v[32:39], v12
    v_exp_f32 v42, v42
    v_exp_f32 v43, v43
    v_exp_f32 v44, v44
    v_exp_f32 v45, v45
    v_exp_f32 v46, v46
    v_exp_f32 v47, v47
    v_exp_f32 v16, v16
    v_exp_f32 v17, v17
    v_smfmac_f32_32x32x32_bf16 v[64:79], v[144:147], v[40:47], v12
    v_exp_f32 v18, v18
    v_exp_f32 v19, v19
    v_exp_f32 v20, v20
    v_mfma_f32_32x32x16_bf16 v[32:47], v[136:139], v[152:155], 0
    v_exp_f32 v21, v21
    v_exp_f32 v22, v22
    v_exp_f32 v23, v23
    v_exp_f32 v24, v24
    v_exp_f32 v25, v25
    v_smfmac_f32_32x32x32_bf16 v[80:95], v[140:143], v[16:23], v12
    v_exp_f32 v26, v26
    v_exp_f32 v27, v27
    v_exp_f32 v28, v28
    v_exp_f32 v29, v29
    v_exp_f32 v30, v30
    v_exp_f32 v31, v31
    v_exp_f32 v32, v32
    v_exp_f32 v33, v33
    v_smfmac_f32_32x32x32_bf16 v[80:95], v[144:147], v[24:31], v12
    v_exp_f32 v34, v34
    v_exp_f32 v35, v35
    v_exp_f32 v36, v36
    s_waitcnt vmcnt(3)
    v_mfma_f32_32x32x16_bf16 v[16:31], v[112:115], v[4:7], 0
    v_exp_f32 v37, v37
    v_exp_f32 v38, v38
    v_exp_f32 v39, v39
    v_exp_f32 v40, v40
    v_exp_f32 v41, v41
    v_smfmac_f32_32x32x32_bf16 v[96:111], v[140:143], v[32:39], v12
    v_exp_f32 v42, v42
    v_exp_f32 v43, v43
    v_exp_f32 v44, v44
    v_exp_f32 v45, v45
    v_exp_f32 v46, v46
    v_exp_f32 v47, v47
    v_exp_f32 v16, v16
    v_exp_f32 v17, v17
    v_smfmac_f32_32x32x32_bf16 v[96:111], v[144:147], v[40:47], v12
    v_exp_f32 v18, v18
    buffer_load_dwordx4 v[136:139], v13, s[56:59], s83 offen sc1
    v_exp_f32 v19, v19
    s_mov_b64 exec, s[88:89]
    buffer_load_dwordx4 v[140:143], v14, s[56:59], s83 offen offset:1024 sc1
    buffer_load_dwordx4 v[144:147], v14, s[56:59], s83 offen offset:1536 sc1
    s_mov_b64 exec, -1
    s_add_u32 s83, s83, 4096
    s_and_b32 s83, s83, 0x1ffff
    s_or_b32 s83, s83, s84
    v_exp_f32 v20, v20
    v_mfma_f32_32x32x16_bf16 v[32:47], v[112:115], v[8:11], 0
    v_exp_f32 v21, v21
    v_exp_f32 v22, v22
    v_exp_f32 v23, v23
    v_exp_f32 v24, v24
    v_exp_f32 v25, v25
    v_smfmac_f32_32x32x32_bf16 v[48:63], v[116:119], v[16:23], v12
    v_exp_f32 v26, v26
    v_exp_f32 v27, v27
    buffer_load_dword v255, v13, s[56:59], s77 offen sc1
    buffer_load_dword v255, off, s[56:59], s78 sc1
    v_exp_f32 v28, v28
    v_exp_f32 v29, v29
    v_exp_f32 v30, v30
    v_exp_f32 v31, v31
    v_exp_f32 v32, v32
    v_exp_f32 v33, v33
    v_smfmac_f32_32x32x32_bf16 v[48:63], v[120:123], v[24:31], v12
    v_exp_f32 v34, v34
    v_exp_f32 v35, v35
    v_exp_f32 v36, v36
    v_mfma_f32_32x32x16_bf16 v[16:31], v[112:115], v[148:151], 0
    v_exp_f32 v37, v37
    v_exp_f32 v38, v38
    v_exp_f32 v39, v39
    v_exp_f32 v40, v40
    v_exp_f32 v41, v41
    v_smfmac_f32_32x32x32_bf16 v[64:79], v[116:119], v[32:39], v12
    v_exp_f32 v42, v42
    v_exp_f32 v43, v43
    v_exp_f32 v44, v44
    v_exp_f32 v45, v45
    v_exp_f32 v46, v46
    v_exp_f32 v47, v47
    v_exp_f32 v16, v16
    v_exp_f32 v17, v17
    v_smfmac_f32_32x32x32_bf16 v[64:79], v[120:123], v[40:47], v12
    v_exp_f32 v18, v18
    v_exp_f32 v19, v19
    v_exp_f32 v20, v20
    v_mfma_f32_32x32x16_bf16 v[32:47], v[112:115], v[152:155], 0
    v_exp_f32 v21, v21
    v_exp_f32 v22, v22
    v_exp_f32 v23, v23
    v_exp_f32 v24, v24
    v_exp_f32 v25, v25
    v_smfmac_f32_32x32x32_bf16 v[80:95], v[116:119], v[16:23], v12
    v_exp_f32 v26, v26
    v_exp_f32 v27, v27
    v_exp_f32 v28, v28
    v_exp_f32 v29, v29
    v_exp_f32 v30, v30
    v_exp_f32 v31, v31
    v_exp_f32 v32, v32
    v_exp_f32 v33, v33
    v_smfmac_f32_32x32x32_bf16 v[80:95], v[120:123], v[24:31], v12
    v_exp_f32 v34, v34
    v_exp_f32 v35, v35
    v_exp_f32 v36, v36
    s_waitcnt vmcnt(5)
    v_mfma_f32_32x32x16_bf16 v[16:31], v[124:127], v[4:7], 0
    v_exp_f32 v37, v37
    v_exp_f32 v38, v38
    v_exp_f32 v39, v39
    v_exp_f32 v40, v40
    v_exp_f32 v41, v41
    v_smfmac_f32_32x32x32_bf16 v[96:111], v[116:119], v[32:39], v12
    v_exp_f32 v42, v42
    v_exp_f32 v43, v43
    v_exp_f32 v44, v44
    v_exp_f32 v45, v45
    v_exp_f32 v46, v46
    v_exp_f32 v47, v47
    v_exp_f32 v16, v16
    v_exp_f32 v17, v17
    v_smfmac_f32_32x32x32_bf16 v[96:111], v[120:123], v[40:47], v12
    v_exp_f32 v18, v18
    buffer_load_dwordx4 v[112:115], v13, s[56:59], s83 offen sc1
    v_exp_f32 v19, v19
    s_mov_b64 exec, s[88:89]
    buffer_load_dwordx4 v[116:119], v14, s[56:59], s83 offen offset:1024 sc1
    buffer_load_dwordx4 v[120:123], v14, s[56:59], s83 offen offset:1536 sc1
    s_mov_b64 exec, -1
    s_add_u32 s83, s83, 4096
    v_exp_f32 v20, v20
    v_mfma_f32_32x32x16_bf16 v[32:47], v[124:127], v[8:11], 0
    v_exp_f32 v21, v21
    v_exp_f32 v22, v22
    v_exp_f32 v23, v23
    v_exp_f32 v24, v24
    v_exp_f32 v25, v25
    v_smfmac_f32_32x32x32_bf16 v[48:63], v[128:131], v[16:23], v12
    v_exp_f32 v26, v26
    v_exp_f32 v27, v27
    buffer_load_dwordx2 v[236:237], v232, s[56:59], s75 offen sc1
    buffer_load_dwordx2 v[238:239], v233, s[56:59], 0 offen sc1
    v_exp_f32 v28, v28
    v_exp_f32 v29, v29
    v_exp_f32 v30, v30
    v_exp_f32 v31, v31
    v_exp_f32 v32, v32
    v_exp_f32 v33, v33
    v_smfmac_f32_32x32x32_bf16 v[48:63], v[132:135], v[24:31], v12
    v_exp_f32 v34, v34
    v_exp_f32 v35, v35
    v_exp_f32 v36, v36
    v_mfma_f32_32x32x16_bf16 v[16:31], v[124:127], v[148:151], 0
    v_exp_f32 v37, v37
    v_exp_f32 v38, v38
    v_exp_f32 v39, v39
    v_exp_f32 v40, v40
    v_exp_f32 v41, v41
    v_smfmac_f32_32x32x32_bf16 v[64:79], v[128:131], v[32:39], v12
    v_exp_f32 v42, v42
    v_exp_f32 v43, v43
    v_exp_f32 v44, v44
    v_exp_f32 v45, v45
    v_exp_f32 v46, v46
    v_exp_f32 v47, v47
    v_exp_f32 v16, v16
    v_exp_f32 v17, v17
    v_smfmac_f32_32x32x32_bf16 v[64:79], v[132:135], v[40:47], v12
    v_exp_f32 v18, v18
    v_exp_f32 v19, v19
    v_exp_f32 v20, v20
    v_mfma_f32_32x32x16_bf16 v[32:47], v[124:127], v[152:155], 0
    v_exp_f32 v21, v21
    v_exp_f32 v22, v22
    v_exp_f32 v23, v23
    v_exp_f32 v24, v24
    v_exp_f32 v25, v25
    v_smfmac_f32_32x32x32_bf16 v[80:95], v[128:131], v[16:23], v12
    v_exp_f32 v26, v26
    v_exp_f32 v27, v27
    v_exp_f32 v28, v28
    v_exp_f32 v29, v29
    v_exp_f32 v30, v30
    v_exp_f32 v31, v31
    v_exp_f32 v32, v32
    v_exp_f32 v33, v33
    v_smfmac_f32_32x32x32_bf16 v[80:95], v[132:135], v[24:31], v12
    v_exp_f32 v34, v34
    v_exp_f32 v35, v35
    v_exp_f32 v36, v36
    s_waitcnt vmcnt(7)
    v_mfma_f32_32x32x16_bf16 v[16:31], v[136:139], v[4:7], 0
    v_exp_f32 v37, v37
    v_exp_f32 v38, v38
    v_exp_f32 v39, v39
    v_exp_f32 v40, v40
    v_exp_f32 v41, v41
    v_smfmac_f32_32x32x32_bf16 v[96:111], v[128:131], v[32:39], v12
    v_exp_f32 v42, v42
    v_exp_f32 v43, v43
    v_exp_f32 v44, v44
    v_exp_f32 v45, v45
    v_exp_f32 v46, v46
    v_exp_f32 v47, v47
    v_exp_f32 v16, v16
    v_exp_f32 v17, v17
    v_smfmac_f32_32x32x32_bf16 v[96:111], v[132:135], v[40:47], v12
    v_exp_f32 v18, v18
    buffer_load_dwordx4 v[124:127], v13, s[56:59], s83 offen sc1
    v_exp_f32 v19, v19
    s_mov_b64 exec, s[88:89]
    buffer_load_dwordx4 v[128:131], v14, s[56:59], s83 offen offset:1024 sc1
    buffer_load_dwordx4 v[132:135], v14, s[56:59], s83 offen offset:1536 sc1
    s_mov_b64 exec, -1
    s_add_u32 s83, s83, 4096
    v_exp_f32 v20, v20
    v_mfma_f32_32x32x16_bf16 v[32:47], v[136:139], v[8:11], 0
    v_exp_f32 v21, v21
    v_exp_f32 v22, v22
    v_exp_f32 v23, v23
    v_exp_f32 v24, v24
    v_exp_f32 v25, v25
    v_smfmac_f32_32x32x32_bf16 v[48:63], v[140:143], v[16:23], v12
    v_exp_f32 v26, v26
    v_exp_f32 v27, v27
    v_exp_f32 v28, v28
    v_exp_f32 v29, v29
    v_exp_f32 v30, v30
    v_exp_f32 v31, v31
    v_exp_f32 v32, v32
    v_exp_f32 v33, v33
    v_smfmac_f32_32x32x32_bf16 v[48:63], v[144:147], v[24:31], v12
    v_exp_f32 v34, v34
    v_exp_f32 v35, v35
    v_exp_f32 v36, v36
    v_mfma_f32_32x32x16_bf16 v[16:31], v[136:139], v[148:151], 0
    v_exp_f32 v37, v37
    v_exp_f32 v38, v38
    v_exp_f32 v39, v39
    v_exp_f32 v40, v40
    v_exp_f32 v41, v41
    v_smfmac_f32_32x32x32_bf16 v[64:79], v[140:143], v[32:39], v12
    v_exp_f32 v42, v42
    v_exp_f32 v43, v43
    v_exp_f32 v44, v44
    v_exp_f32 v45, v45
    v_exp_f32 v46, v46
    v_exp_f32 v47, v47
    s_cmp_lg_u32 s82, 1
    s_cbranch_scc1 L_pr_45
    s_setprio 2
L_pr_45:
    v_exp_f32 v16, v16
    v_exp_f32 v17, v17
    v_smfmac_f32_32x32x32_bf16 v[64:79], v[144:147], v[40:47], v12
    v_exp_f32 v18, v18
    v_exp_f32 v19, v19
    v_exp_f32 v20, v20
    v_mfma_f32_32x32x16_bf16 v[32:47], v[136:139], v[152:155], 0
    v_exp_f32 v21, v21
    v_exp_f32 v22, v22
    v_exp_f32 v23, v23
    v_exp_f32 v24, v24
    v_exp_f32 v25, v25
    v_smfmac_f32_32x32x32_bf16 v[80:95], v[140:143], v[16:23], v12
    v_exp_f32 v26, v26
    v_exp_f32 v27, v27
    v_exp_f32 v28, v28
    v_exp_f32 v29, v29
    v_exp_f32 v30, v30
    v_exp_f32 v31, v31
    v_exp_f32 v32, v32
    v_exp_f32 v33, v33
    v_smfmac_f32_32x32x32_bf16 v[80:95], v[144:147], v[24:31], v12
    v_exp_f32 v34, v34
    v_exp_f32 v35, v35
    v_exp_f32 v36, v36
    s_waitcnt vmcnt(5)
    v_mfma_f32_32x32x16_bf16 v[16:31], v[112:115], v[4:7], 0
    v_exp_f32 v37, v37
    v_exp_f32 v38, v38
    v_exp_f32 v39, v39
    v_exp_f32 v40, v40
    v_exp_f32 v41, v41
    v_smfmac_f32_32x32x32_bf16 v[96:111], v[140:143], v[32:39], v12
    v_exp_f32 v42, v42
    v_exp_f32 v43, v43
    v_exp_f32 v44, v44
    v_exp_f32 v45, v45
    v_exp_f32 v46, v46
    v_exp_f32 v47, v47
    v_exp_f32 v16, v16
    v_exp_f32 v17, v17
    v_smfmac_f32_32x32x32_bf16 v[96:111], v[144:147], v[40:47], v12
    v_exp_f32 v18, v18
    buffer_load_dwordx4 v[136:139], v13, s[56:59], s83 offen sc1
    v_exp_f32 v19, v19
    s_mov_b64 exec, s[88:89]
    buffer_load_dwordx4 v[140:143], v14, s[56:59], s83 offen offset:1024 sc1
    buffer_load_dwordx4 v[144:147], v14, s[56:59], s83 offen offset:1536 sc1
    s_mov_b64 exec, -1
    s_add_u32 s83, s83, 4096
    v_exp_f32 v20, v20
    v_mfma_f32_32x32x16_bf16 v[32:47], v[112:115], v[8:11], 0
    v_exp_f32 v21, v21
    v_exp_f32 v22, v22
    v_exp_f32 v23, v23
    v_exp_f32 v24, v24
    v_exp_f32 v25, v25
    v_smfmac_f32_32x32x32_bf16 v[48:63], v[116:119], v[16:23], v12
    v_exp_f32 v26, v26
    v_exp_f32 v27, v27
    v_exp_f32 v28, v28
    v_exp_f32 v29, v29
    v_exp_f32 v30, v30
    v_exp_f32 v31, v31
    v_exp_f32 v32, v32
    v_exp_f32 v33, v33
    v_smfmac_f32_32x32x32_bf16 v[48:63], v[120:123], v[24:31], v12
    v_exp_f32 v34, v34
    v_exp_f32 v35, v35
    v_exp_f32 v36, v36
    v_mfma_f32_32x32x16_bf16 v[16:31], v[112:115], v[148:151], 0
    v_exp_f32 v37, v37
    v_exp_f32 v38, v38
    v_exp_f32 v39, v39
    v_exp_f32 v40, v40
    v_exp_f32 v41, v41
    v_smfmac_f32_32x32x32_bf16 v[64:79], v[116:119], v[32:39], v12
    v_exp_f32 v42, v42
    v_exp_f32 v43, v43
    v_exp_f32 v44, v44
    v_exp_f32 v45, v45
    v_exp_f32 v46, v46
    v_exp_f32 v47, v47
    v_exp_f32 v16, v16
    v_exp_f32 v17, v17
    v_smfmac_f32_32x32x32_bf16 v[64:79], v[120:123], v[40:47], v12
    v_exp_f32 v18, v18
    v_exp_f32 v19, v19
    v_exp_f32 v20, v20
    v_mfma_f32_32x32x16_bf16 v[32:47], v[112:115], v[152:155], 0
    v_exp_f32 v21, v21
    v_exp_f32 v22, v22
    v_exp_f32 v23, v23
    v_exp_f32 v24, v24
    v_exp_f32 v25, v25
    v_smfmac_f32_32x32x32_bf16 v[80:95], v[116:119], v[16:23], v12
    v_exp_f32 v26, v26
    v_exp_f32 v27, v27
    v_exp_f32 v28, v28
    v_exp_f32 v29, v29
    v_exp_f32 v30, v30
    v_exp_f32 v31, v31
    v_exp_f32 v32, v32
    v_exp_f32 v33, v33
    v_smfmac_f32_32x32x32_bf16 v[80:95], v[120:123], v[24:31], v12
    v_exp_f32 v34, v34
    v_exp_f32 v35, v35
    v_exp_f32 v36, v36
    s_waitcnt vmcnt(3)
    v_mfma_f32_32x32x16_bf16 v[16:31], v[124:127], v[4:7], 0
    v_exp_f32 v37, v37
    v_exp_f32 v38, v38
    v_exp_f32 v39, v39
    v_exp_f32 v40, v40
    v_exp_f32 v41, v41
    v_smfmac_f32_32x32x32_bf16 v[96:111], v[116:119], v[32:39], v12
    v_exp_f32 v42, v42
    v_exp_f32 v43, v43
    v_exp_f32 v44, v44
    v_exp_f32 v45, v45
    v_exp_f32 v46, v46
    v_exp_f32 v47, v47
    v_exp_f32 v16, v16
    v_exp_f32 v17, v17
    v_smfmac_f32_32x32x32_bf16 v[96:111], v[120:123], v[40:47], v12
    v_exp_f32 v18, v18
    buffer_load_dwordx4 v[112:115], v13, s[56:59], s83 offen sc1
    v_exp_f32 v19, v19
    s_mov_b64 exec, s[88:89]
    buffer_load_dwordx4 v[116:119], v14, s[56:59], s83 offen offset:1024 sc1
    buffer_load_dwordx4 v[120:123], v14, s[56:59], s83 offen offset:1536 sc1
    s_mov_b64 exec, -1
    v_exp_f32 v20, v20
    v_mfma_f32_32x32x16_bf16 v[32:47], v[124:127], v[8:11], 0
    v_exp_f32 v21, v21
    v_exp_f32 v22, v22
    v_exp_f32 v23, v23
    v_exp_f32 v24, v24
    v_exp_f32 v25, v25
    v_smfmac_f32_32x32x32_bf16 v[48:63], v[128:131], v[16:23], v12
    v_exp_f32 v26, v26
    v_exp_f32 v27, v27
    v_cmp_ne_u32 vcc, s96, v236
    v_cmp_ne_u32 s[92:93], s96, v237
    v_cmp_ne_u32 s[10:11], s96, v238
    s_nop 0
    s_or_b64 vcc, vcc, s[92:93]
    s_or_b64 vcc, vcc, s[10:11]
    s_cbranch_vccnz L_side_slow
L_side_ok:
    v_cmp_ne_u32 vcc, s97, v239
    s_add_u32 m0, s86, 152064
    s_nop 0
    s_or_b32 s90, vcc_lo, vcc_hi
    buffer_load_dwordx4 v234, s[56:59], s74 offen sc1 lds
    v_exp_f32 v28, v28
    v_exp_f32 v29, v29
    v_exp_f32 v30, v30
    v_exp_f32 v31, v31
    v_exp_f32 v32, v32
    v_exp_f32 v33, v33
    v_smfmac_f32_32x32x32_bf16 v[48:63], v[132:135], v[24:31], v12
    v_exp_f32 v34, v34
    v_exp_f32 v35, v35
    v_exp_f32 v36, v36
    v_mfma_f32_32x32x16_bf16 v[16:31], v[124:127], v[148:151], 0
    v_exp_f32 v37, v37
    v_exp_f32 v38, v38
    buffer_load_dword v240, v2, s[56:59], s73 offen offset:0 sc1
    v_exp_f32 v39, v39
    v_exp_f32 v40, v40
    v_exp_f32 v41, v41
    v_smfmac_f32_32x32x32_bf16 v[64:79], v[128:131], v[32:39], v12
    v_exp_f32 v42, v42
    v_exp_f32 v43, v43
    v_exp_f32 v44, v44
    buffer_load_dword v241, v2, s[56:59], s73 offen offset:128 sc1
    v_exp_f32 v45, v45
    v_exp_f32 v46, v46
    v_exp_f32 v47, v47
    v_exp_f32 v16, v16
    v_exp_f32 v17, v17
    v_smfmac_f32_32x32x32_bf16 v[64:79], v[132:135], v[40:47], v12
    v_exp_f32 v18, v18
    buffer_load_dword v242, v2, s[56:59], s73 offen offset:256 sc1
    v_exp_f32 v19, v19
    v_exp_f32 v20, v20
    v_mfma_f32_32x32x16_bf16 v[32:47], v[124:127], v[152:155], 0
    v_exp_f32 v21, v21
    v_exp_f32 v22, v22
    v_exp_f32 v23, v23
    v_exp_f32 v24, v24
    buffer_load_dword v243, v2, s[56:59], s73 offen offset:384 sc1
    v_exp_f32 v25, v25
    v_smfmac_f32_32x32x32_bf16 v[80:95], v[128:131], v[16:23], v12
    v_exp_f32 v26, v26
    v_exp_f32 v27, v27
    v_exp_f32 v28, v28
    v_exp_f32 v29, v29
    v_exp_f32 v30, v30
    v_exp_f32 v31, v31
    s_cmp_lg_u32 s82, 0
    s_cbranch_scc1 L_pr_46
    s_setprio 1
L_pr_46:
    v_exp_f32 v32, v32
    v_exp_f32 v33, v33
    v_smfmac_f32_32x32x32_bf16 v[80:95], v[132:135], v[24:31], v12
    v_exp_f32 v34, v34
    v_exp_f32 v35, v35
    v_exp_f32 v36, v36
    s_waitcnt vmcnt(8)
    v_mfma_f32_32x32x16_bf16 v[16:31], v[136:139], v[4:7], 0
    v_exp_f32 v37, v37
    v_exp_f32 v38, v38
    v_exp_f32 v39, v39
    v_exp_f32 v40, v40
    v_exp_f32 v41, v41
    v_smfmac_f32_32x32x32_bf16 v[96:111], v[128:131], v[32:39], v12
    v_exp_f32 v42, v42
    v_exp_f32 v43, v43
    v_exp_f32 v44, v44
    v_exp_f32 v45, v45
    v_exp_f32 v46, v46
    v_exp_f32 v47, v47
    v_exp_f32 v16, v16
    v_exp_f32 v17, v17
    v_smfmac_f32_32x32x32_bf16 v[96:111], v[132:135], v[40:47], v12
    v_exp_f32 v18, v18
    v_exp_f32 v19, v19
    v_exp_f32 v20, v20
    v_mfma_f32_32x32x16_bf16 v[32:47], v[136:139], v[8:11], 0
    v_exp_f32 v21, v21
    v_exp_f32 v22, v22
    s_add_u32 m0, s86, 0
    v_exp_f32 v23, v23
    buffer_load_dwordx4 v15, s[60:63], s85 offen lds
    s_add_u32 s85, s85, 0x10000
    v_exp_f32 v24, v24
    v_exp_f32 v25, v25
    v_smfmac_f32_32x32x32_bf16 v[48:63], v[140:143], v[16:23], v12
    v_exp_f32 v26, v26
    v_exp_f32 v27, v27
    v_exp_f32 v28, v28
    v_exp_f32 v29, v29
    s_add_u32 m0, s86, 8192
    v_exp_f32 v30, v30
    buffer_load_dwordx4 v15, s[60:63], s85 offen lds
    s_add_u32 s85, s85, 0x10000
    v_exp_f32 v31, v31
    v_exp_f32 v32, v32
    v_exp_f32 v33, v33
    v_smfmac_f32_32x32x32_bf16 v[48:63], v[144:147], v[24:31], v12
    v_exp_f32 v34, v34
    v_exp_f32 v35, v35
    v_exp_f32 v36, v36
    v_mfma_f32_32x32x16_bf16 v[16:31], v[136:139], v[148:151], 0
    v_exp_f32 v37, v37
    v_exp_f32 v38, v38
    s_add_u32 m0, s86, 16384
    v_exp_f32 v39, v39
    buffer_load_dwordx4 v15, s[60:63], s85 offen lds
    s_add_u32 s85, s85, 0x10000
    v_exp_f32 v40, v40
    v_exp_f32 v41, v41
    v_smfmac_f32_32x32x32_bf16 v[64:79], v[140:143], v[32:39], v12
    v_exp_f32 v42, v42
    v_exp_f32 v43, v43
    v_exp_f32 v44, v44
    v_exp_f32 v45, v45
    s_add_u32 m0, s86, 24576
    v_exp_f32 v46, v46
    buffer_load_dwordx4 v15, s[60:63], s85 offen lds
    s_add_u32 s85, s85, 0x10000
    v_exp_f32 v47, v47
    v_exp_f32 v16, v16
    v_exp_f32 v17, v17
    v_smfmac_f32_32x32x32_bf16 v[64:79], v[144:147], v[40:47], v12
    v_exp_f32 v18, v18
    v_exp_f32 v19, v19
    v_exp_f32 v20, v20
    v_mfma_f32_32x32x16_bf16 v[32:47], v[136:139], v[152:155], 0
    v_exp_f32 v21, v21
    v_exp_f32 v22, v22
    s_add_u32 m0, s86, 32768
    v_exp_f32 v23, v23
    buffer_load_dwordx4 v15, s[60:63], s85 offen lds
    s_add_u32 s85, s85, 0x10000
    v_exp_f32 v24, v24
    v_exp_f32 v25, v25
    v_smfmac_f32_32x32x32_bf16 v[80:95], v[140:143], v[16:23], v12
    v_exp_f32 v26, v26
    v_exp_f32 v27, v27
    v_exp_f32 v28, v28
    v_exp_f32 v29, v29
    s_add_u32 m0, s86, 40960
    v_exp_f32 v30, v30
    buffer_load_dwordx4 v15, s[60:63], s85 offen lds
    s_add_u32 s85, s85, 0x10000
    v_exp_f32 v31, v31
    v_exp_f32 v32, v32
    v_exp_f32 v33, v33
    v_smfmac_f32_32x32x32_bf16 v[80:95], v[144:147], v[24:31], v12
    v_exp_f32 v34, v34
    v_exp_f32 v35, v35
    v_exp_f32 v36, v36
    s_waitcnt vmcnt(11)
    v_mfma_f32_32x32x16_bf16 v[16:31], v[112:115], v[4:7], 0
    v_exp_f32 v37, v37
    v_exp_f32 v38, v38
    s_add_u32 m0, s86, 49152
    v_exp_f32 v39, v39
    buffer_load_dwordx4 v15, s[60:63], s85 offen lds
    s_add_u32 s85, s85, 0x10000
    v_exp_f32 v40, v40
    v_exp_f32 v41, v41
    v_smfmac_f32_32x32x32_bf16 v[96:111], v[140:143], v[32:39], v12
    v_exp_f32 v42, v42
    v_exp_f32 v43, v43
    s_add_u32 m0, s86, 57344
    v_exp_f32 v44, v44
    buffer_load_dwordx4 v15, s[60:63], s85 offen lds
    s_add_u32 s85, s85, 0x10000
    v_exp_f32 v45, v45
    v_exp_f32 v46, v46
    v_exp_f32 v47, v47
    s_cmp_lg_u32 s82, 1
    s_cbranch_scc1 L_pr_47
    s_setprio 1
L_pr_47:
    v_exp_f32 v16, v16
    v_exp_f32 v17, v17
    v_smfmac_f32_32x32x32_bf16 v[96:111], v[144:147], v[40:47], v12
    v_exp_f32 v18, v18
    v_exp_f32 v19, v19
    v_exp_f32 v20, v20
    v_mfma_f32_32x32x16_bf16 v[32:47], v[112:115], v[8:11], 0
    v_exp_f32 v21, v21
    v_exp_f32 v22, v22
    v_exp_f32 v23, v23
    v_exp_f32 v24, v24
    v_exp_f32 v25, v25
    v_smfmac_f32_32x32x32_bf16 v[48:63], v[116:119], v[16:23], v12
    v_exp_f32 v26, v26
    v_exp_f32 v27, v27
    v_exp_f32 v28, v28
    v_exp_f32 v29, v29
    v_exp_f32 v30, v30
    v_exp_f32 v31, v31
    v_exp_f32 v32, v32
    v_exp_f32 v33, v33
    v_smfmac_f32_32x32x32_bf16 v[48:63], v[120:123], v[24:31], v12
    v_exp_f32 v34, v34
    v_exp_f32 v35, v35
    v_exp_f32 v36, v36
    v_mfma_f32_32x32x16_bf16 v[16:31], v[112:115], v[148:151], 0
    v_exp_f32 v37, v37
    v_exp_f32 v38, v38
    v_exp_f32 v39, v39
    v_exp_f32 v40, v40
    v_exp_f32 v41, v41
    v_smfmac_f32_32x32x32_bf16 v[64:79], v[116:119], v[32:39], v12
    v_exp_f32 v42, v42
    v_exp_f32 v43, v43
    v_exp_f32 v44, v44
    v_exp_f32 v45, v45
    v_exp_f32 v46, v46
    v_exp_f32 v47, v47
    v_exp_f32 v16, v16
    v_exp_f32 v17, v17
    v_smfmac_f32_32x32x32_bf16 v[64:79], v[120:123], v[40:47], v12
    v_exp_f32 v18, v18
    s_add_u32 s8, s3, 2
    s_and_b32 s8, s8, 7
    s_mul_i32 s8, s8, 6912
    s_add_u32 s8, s8, 65536
    v_add_u32 v244, s8, v13
    v_add_u32 v245, s8, v235
    v_exp_f32 v19, v19
    ds_write_b32 v245, v56 offset:2048
    v_exp_f32 v20, v20
    v_mfma_f32_32x32x16_bf16 v[32:47], v[112:115], v[152:155], 0
    ds_write_b128 v244, v[48:51]
    v_exp_f32 v21, v21
    v_exp_f32 v22, v22
    ds_write_b128 v244, v[52:55] offset:1024
    v_exp_f32 v23, v23
    v_exp_f32 v24, v24
    v_exp_f32 v25, v25
    v_smfmac_f32_32x32x32_bf16 v[80:95], v[116:119], v[16:23], v12
    v_exp_f32 v26, v26
    v_exp_f32 v27, v27
    v_exp_f32 v28, v28
    v_exp_f32 v29, v29
    v_exp_f32 v30, v30
    v_exp_f32 v31, v31
    s_cmp_lg_u32 s82, 0
    s_cbranch_scc1 L_pr_48
    s_setprio 0
L_pr_48:
    v_exp_f32 v32, v32
    v_exp_f32 v33, v33
    v_smfmac_f32_32x32x32_bf16 v[80:95], v[120:123], v[24:31], v12
    v_exp_f32 v34, v34
    s_add_u32 s8, s3, 4
    s_and_b32 s8, s8, 7
    s_mul_i32 s8, s8, 6912
    s_add_u32 s8, s8, 67840
    v_add_u32 v244, s8, v13
    v_add_u32 v245, s8, v235
    v_exp_f32 v35, v35
    ds_write_b32 v245, v72 offset:2048
    v_exp_f32 v36, v36
    ds_write_b128 v244, v[64:67]
    v_exp_f32 v37, v37
    v_exp_f32 v38, v38
    ds_write_b128 v244, v[68:71] offset:1024
    v_exp_f32 v39, v39
    v_exp_f32 v40, v40
    v_exp_f32 v41, v41
    v_smfmac_f32_32x32x32_bf16 v[96:111], v[116:119], v[32:39], v12
    v_exp_f32 v42, v42
    s_add_u32 s8, s3, 6
    s_and_b32 s8, s8, 7
    s_mul_i32 s8, s8, 6912
    s_add_u32 s8, s8, 70144
    v_add_u32 v244, s8, v13
    v_add_u32 v245, s8, v235
    v_exp_f32 v43, v43
    ds_write_b32 v245, v88 offset:2048
    v_exp_f32 v44, v44
    ds_write_b128 v244, v[80:83]
    v_exp_f32 v45, v45
    v_exp_f32 v46, v46
    ds_write_b128 v244, v[84:87] offset:1024
    v_exp_f32 v47, v47
    s_nop 1
    v_smfmac_f32_32x32x32_bf16 v[96:111], v[120:123], v[40:47], v12
    s_setprio 3
    s_mul_i32 s8, s3, 6912
    s_add_u32 s8, s8, 65536
    v_add_u32 v246, s8, v13
    v_add_u32 v247, s8, v235
    s_mov_b32 s12, 0x33800000
    s_mov_b32 s13, 0x57800000
    s_mov_b32 s14, 0x7b800000
    s_mov_b32 s15, 0
    s_waitcnt vmcnt(0) lgkmcnt(0)
    s_barrier
    ds_read_b32 v72, v247 offset:2048
    ds_read_b32 v73, v247 offset:4352
    ds_read_b32 v74, v247 offset:6656
    ds_read_b128 v[48:51], v246 offset:0
    ds_read_b128 v[52:55], v246 offset:1024
    ds_read_b128 v[56:59], v246 offset:2304
    ds_read_b128 v[60:63], v246 offset:3328
    ds_read_b128 v[64:67], v246 offset:4608
    ds_read_b128 v[68:71], v246 offset:5632
    s_waitcnt lgkmcnt(6)
    v_add_f32 v72, v72, v73
    v_add_f32 v104, v104, v74
    v_add_f32 v104, v104, v72
    s_waitcnt lgkmcnt(5)
    v_pk_add_f32 v[96:97], v[96:97], v[48:49]
    v_pk_add_f32 v[98:99], v[98:99], v[50:51]
    s_waitcnt lgkmcnt(4)
    v_pk_add_f32 v[100:101], v[100:101], v[52:53]
    v_pk_add_f32 v[102:103], v[102:103], v[54:55]
    s_waitcnt lgkmcnt(3)
    v_pk_add_f32 v[96:97], v[96:97], v[56:57]
    v_pk_add_f32 v[98:99], v[98:99], v[58:59]
    s_waitcnt lgkmcnt(2)
    v_pk_add_f32 v[100:101], v[100:101], v[60:61]
    v_pk_add_f32 v[102:103], v[102:103], v[62:63]
    s_waitcnt lgkmcnt(1)
    v_pk_add_f32 v[96:97], v[96:97], v[64:65]
    v_pk_add_f32 v[98:99], v[98:99], v[66:67]
    s_waitcnt lgkmcnt(0)
    v_pk_add_f32 v[100:101], v[100:101], v[68:69]
    v_pk_add_f32 v[102:103], v[102:103], v[70:71]
L_norm:
    v_rcp_f32 v28, v104
    s_nop 0
    v_pk_mul_f32 v[32:33], v[96:97], v[28:29] op_sel_hi:[1,0]
    v_pk_mul_f32 v[34:35], v[98:99], v[28:29] op_sel_hi:[1,0]
    v_pk_mul_f32 v[36:37], v[100:101], v[28:29] op_sel_hi:[1,0]
    v_pk_mul_f32 v[38:39], v[102:103], v[28:29] op_sel_hi:[1,0]
    v_cvt_pk_bf16_f32 v20, v32, v33
    v_cvt_pk_bf16_f32 v21, v34, v35
    v_cvt_pk_bf16_f32 v22, v36, v37
    v_cvt_pk_bf16_f32 v23, v38, v39
    s_cmp_lg_u32 s90, 0
    s_cbranch_scc1 L_el_49
    buffer_store_dwordx4 v[20:23], v13, s[56:59], s77 offen nt
    s_branch L_fi_50
L_el_49:
    buffer_store_dwordx4 v[20:23], v13, s[56:59], s77 offen sc1
L_fi_50:
    v_add_f32 v28, abs(v96), abs(v97)
    v_add_f32 v28, v28, abs(v98)
    v_add_f32 v28, v28, abs(v99)
    v_add_f32 v28, v28, abs(v100)
    v_add_f32 v28, v28, abs(v101)
    v_add_f32 v28, v28, abs(v102)
    v_add_f32 v28, v28, abs(v103)
    v_cmp_nle_f32 s[10:11], s12, v104
    v_cmp_nge_f32 s[92:93], s13, v104
    v_cmp_nge_f32 vcc, s14, v28
    s_nop 0
    s_or_b64 s[10:11], s[10:11], s[92:93]
    s_or_b64 s[10:11], s[10:11], vcc
    s_cbranch_scc1 L_fallback
L_checked:
    s_cmp_lg_u32 s82, 0
    s_cbranch_scc1 L_tail_b
    v_mov_b32 v4, v220
    v_mov_b32 v5, v221
    v_mov_b32 v6, v222
    v_mov_b32 v7, v223
    v_mov_b32 v8, v224
    v_mov_b32 v9, v225
    v_mov_b32 v12, v226
    v_pk_add_f32 v[240:241], v[240:241], v[242:243]
    v_add_f32 v15, v240, v241
    s_waitcnt vmcnt(0)
    s_mov_b64 exec, 1
    v_mov_b32 v1, s96
    s_cmp_lg_u32 s90, 0
    s_cbranch_scc1 L_el_51
    buffer_store_dword v1, off, s[56:59], s78
    s_branch L_fi_52
L_el_51:
    buffer_store_dword v1, off, s[56:59], s78 sc1
L_fi_52:
    s_mov_b64 exec, -1
    ds_read_b64_tr_b16 v[24:25], v6 offset:0
    ds_read_b64_tr_b16 v[26:27], v6 offset:512
    ds_read_b64_tr_b16 v[28:29], v6 offset:1024
    ds_read_b64_tr_b16 v[30:31], v6 offset:1536
    ds_read_b64_tr_b16 v[128:129], v4 offset:0
    ds_read_b64_tr_b16 v[130:131], v4 offset:1024
    ds_read_b64_tr_b16 v[132:133], v5 offset:0
    ds_read_b64_tr_b16 v[134:135], v5 offset:1024
    ds_read_b64_tr_b16 v[136:137], v4 offset:2048
    ds_read_b64_tr_b16 v[138:139], v4 offset:3072
    ds_read_b64_tr_b16 v[140:141], v5 offset:2048
    ds_read_b64_tr_b16 v[142:143], v5 offset:3072
    s_mov_b32 s8, 400000
L_pl_53:
    buffer_load_dword v14, v12, s[56:59], s76 offen sc1
L_ple_55:
    s_waitcnt vmcnt(0)
    v_cmp_ne_u32 vcc, s96, v14
    s_nop 1
    s_cbranch_vccz L_pld_54
    s_mov_b64 exec, vcc
    s_sub_u32 s8, s8, 1
    s_cmp_lg_u32 s8, 0
    s_cbranch_scc1 L_pl_53
L_pld_54:
    s_mov_b64 exec, -1
    buffer_load_dwordx4 v[64:67], v13, s[56:59], s87 offen offset:0 sc1
    ds_read_b64_tr_b16 v[144:145], v4 offset:4096
    ds_read_b64_tr_b16 v[146:147], v4 offset:5120
    ds_read_b64_tr_b16 v[148:149], v5 offset:4096
    ds_read_b64_tr_b16 v[150:151], v5 offset:5120
    buffer_load_dwordx4 v[68:71], v13, s[56:59], s87 offen offset:2048 sc1
    s_add_u32 s87, s87, 4096
    ds_read_b64_tr_b16 v[152:153], v4 offset:6144
    ds_read_b64_tr_b16 v[154:155], v4 offset:7168
    ds_read_b64_tr_b16 v[156:157], v5 offset:6144
    ds_read_b64_tr_b16 v[158:159], v5 offset:7168
    buffer_load_dwordx4 v[72:75], v13, s[56:59], s87 offen offset:0 sc1
    ds_read_b64_tr_b16 v[160:161], v4 offset:8192
    ds_read_b64_tr_b16 v[162:163], v4 offset:9216
    ds_read_b64_tr_b16 v[164:165], v5 offset:8192
    ds_read_b64_tr_b16 v[166:167], v5 offset:9216
    buffer_load_dwordx4 v[76:79], v13, s[56:59], s87 offen offset:2048 sc1
    s_add_u32 s87, s87, 4096
    ds_read_b64_tr_b16 v[168:169], v4 offset:10240
    ds_read_b64_tr_b16 v[170:171], v4 offset:11264
    ds_read_b64_tr_b16 v[172:173], v5 offset:10240
    ds_read_b64_tr_b16 v[174:175], v5 offset:11264
    v_mov_b32 v2, v15
    s_mov_b32 s10, 0xaaaaaaaa
    s_mov_b32 s11, 0xaaaaaaaa
    v_permlane32_swap_b32 v15, v2
    v_add_f32 v15, v15, v2
    v_mul_f32 v15, 0xbfb8aa3b, v15
    v_exp_f32 v15, v15
    s_nop 0
    v_add_f32 v15, 1.0, v15
    v_rcp_f32 v15, v15
    s_nop 0
    v_sub_f32 v10, 1.0, v15
    s_waitcnt vmcnt(3) lgkmcnt(14)
    v_mfma_f32_32x32x16_bf16 v[32:47], v[128:131], v[64:67], 0
    buffer_load_dwordx4 v[80:83], v13, s[56:59], s87 offen offset:0 sc1
    v_mfma_f32_32x32x16_bf16 v[48:63], v[132:135], v[64:67], 0
    ds_read_b64_tr_b16 v[176:177], v4 offset:12288
    ds_read_b64_tr_b16 v[178:179], v4 offset:13312
    ds_read_b64_tr_b16 v[180:181], v5 offset:12288
    ds_read_b64_tr_b16 v[182:183], v5 offset:13312
    s_waitcnt vmcnt(3)
    v_mfma_f32_32x32x16_bf16 v[32:47], v[136:139], v[68:71], v[32:47]
    buffer_load_dwordx4 v[84:87], v13, s[56:59], s87 offen offset:2048 sc1
    s_add_u32 s87, s87, 4096
    v_mfma_f32_32x32x16_bf16 v[48:63], v[140:143], v[68:71], v[48:63]
    ds_read_b64_tr_b16 v[184:185], v4 offset:14336
    ds_read_b64_tr_b16 v[186:187], v4 offset:15360
    ds_read_b64_tr_b16 v[188:189], v5 offset:14336
    ds_read_b64_tr_b16 v[190:191], v5 offset:15360
    s_waitcnt vmcnt(3) lgkmcnt(14)
    v_mfma_f32_32x32x16_bf16 v[32:47], v[144:147], v[72:75], v[32:47]
    buffer_load_dwordx4 v[88:91], v13, s[56:59], s87 offen offset:0 sc1
    v_mfma_f32_32x32x16_bf16 v[48:63], v[148:151], v[72:75], v[48:63]
    ds_read_b64_tr_b16 v[192:193], v4 offset:16384
    ds_read_b64_tr_b16 v[194:195], v4 offset:17408
    ds_read_b64_tr_b16 v[196:197], v5 offset:16384
    ds_read_b64_tr_b16 v[198:199], v5 offset:17408
    s_waitcnt vmcnt(3)
    v_mfma_f32_32x32x16_bf16 v[32:47], v[152:155], v[76:79], v[32:47]
    buffer_load_dwordx4 v[92:95], v13, s[56:59], s87 offen offset:2048 sc1
    s_add_u32 s87, s87, 4096
    v_mfma_f32_32x32x16_bf16 v[48:63], v[156:159], v[76:79], v[48:63]
    ds_read_b64_tr_b16 v[200:201], v4 offset:18432
    ds_read_b64_tr_b16 v[202:203], v4 offset:19456
    ds_read_b64_tr_b16 v[204:205], v5 offset:18432
    ds_read_b64_tr_b16 v[206:207], v5 offset:19456
    s_waitcnt vmcnt(3) lgkmcnt(14)
    v_mfma_f32_32x32x16_bf16 v[32:47], v[160:163], v[80:83], v[32:47]
    buffer_load_dwordx4 v[96:99], v13, s[56:59], s87 offen offset:0 sc1
    v_mfma_f32_32x32x16_bf16 v[48:63], v[164:167], v[80:83], v[48:63]
    ds_read_b64_tr_b16 v[208:209], v4 offset:20480
    ds_read_b64_tr_b16 v[210:211], v4 offset:21504
    ds_read_b64_tr_b16 v[212:213], v5 offset:20480
    ds_read_b64_tr_b16 v[214:215], v5 offset:21504
    s_waitcnt vmcnt(3)
    v_mfma_f32_32x32x16_bf16 v[32:47], v[168:171], v[84:87], v[32:47]
    buffer_load_dwordx4 v[100:103], v13, s[56:59], s87 offen offset:2048 sc1
    s_add_u32 s87, s87, 4096
    v_mfma_f32_32x32x16_bf16 v[48:63], v[172:175], v[84:87], v[48:63]
    ds_read_b64_tr_b16 v[216:217], v4 offset:22528
    ds_read_b64_tr_b16 v[218:219], v4 offset:23552
    ds_read_b64_tr_b16 v[220:221], v5 offset:22528
    ds_read_b64_tr_b16 v[222:223], v5 offset:23552
    s_waitcnt vmcnt(3) lgkmcnt(14)
    v_mfma_f32_32x32x16_bf16 v[32:47], v[176:179], v[88:91], v[32:47]
    buffer_load_dwordx4 v[104:107], v13, s[56:59], s87 offen offset:0 sc1
    v_mfma_f32_32x32x16_bf16 v[48:63], v[180:183], v[88:91], v[48:63]
    ds_read_b64_tr_b16 v[224:225], v4 offset:24576
    ds_read_b64_tr_b16 v[226:227], v4 offset:25600
    ds_read_b64_tr_b16 v[228:229], v5 offset:24576
    ds_read_b64_tr_b16 v[230:231], v5 offset:25600
    v_lshlrev_b32 v16, 16, v24
    v_and_b32 v17, 0xffff0000, v24
    v_mul_f32 v16, v15, v16
    v_mul_f32 v17, v15, v17
    s_waitcnt vmcnt(3)
    v_mfma_f32_32x32x16_bf16 v[32:47], v[184:187], v[92:95], v[32:47]
    buffer_load_dwordx4 v[108:111], v13, s[56:59], s87 offen offset:2048 sc1
    s_add_u32 s87, s87, 4096
    v_mfma_f32_32x32x16_bf16 v[48:63], v[188:191], v[92:95], v[48:63]
    ds_read_b64_tr_b16 v[232:233], v4 offset:26624
    ds_read_b64_tr_b16 v[234:235], v4 offset:27648
    ds_read_b64_tr_b16 v[236:237], v5 offset:26624
    ds_read_b64_tr_b16 v[238:239], v5 offset:27648
    v_lshlrev_b32 v18, 16, v25
    v_and_b32 v19, 0xffff0000, v25
    v_mul_f32 v18, v15, v18
    v_mul_f32 v19, v15, v19
    s_waitcnt vmcnt(3) lgkmcnt(14)
    v_mfma_f32_32x32x16_bf16 v[32:47], v[192:195], v[96:99], v[32:47]
    buffer_load_dwordx4 v[112:115], v13, s[56:59], s87 offen offset:0 sc1
    v_mfma_f32_32x32x16_bf16 v[48:63], v[196:199], v[96:99], v[48:63]
    ds_read_b64_tr_b16 v[240:241], v4 offset:28672
    ds_read_b64_tr_b16 v[242:243], v4 offset:29696
    ds_read_b64_tr_b16 v[244:245], v5 offset:28672
    ds_read_b64_tr_b16 v[246:247], v5 offset:29696
    v_lshlrev_b32 v20, 16, v26
    v_and_b32 v21, 0xffff0000, v26
    v_mul_f32 v20, v15, v20
    v_mul_f32 v21, v15, v21
    s_waitcnt vmcnt(3)
    v_mfma_f32_32x32x16_bf16 v[32:47], v[200:203], v[100:103], v[32:47]
    buffer_load_dwordx4 v[116:119], v13, s[56:59], s87 offen offset:2048 sc1
    s_add_u32 s87, s87, 4096
    v_mfma_f32_32x32x16_bf16 v[48:63], v[204:207], v[100:103], v[48:63]
    ds_read_b64_tr_b16 v[248:249], v4 offset:30720
    ds_read_b64_tr_b16 v[250:251], v4 offset:31744
    ds_read_b64_tr_b16 v[252:253], v5 offset:30720
    ds_read_b64_tr_b16 v[254:255], v5 offset:31744
    v_lshlrev_b32 v22, 16, v27
    v_and_b32 v23, 0xffff0000, v27
    v_mul_f32 v22, v15, v22
    v_mul_f32 v23, v15, v23
    s_waitcnt vmcnt(3) lgkmcnt(14)
    v_mfma_f32_32x32x16_bf16 v[32:47], v[208:211], v[104:107], v[32:47]
    buffer_load_dwordx4 v[120:123], v13, s[56:59], s87 offen offset:0 sc1
    v_mfma_f32_32x32x16_bf16 v[48:63], v[212:215], v[104:107], v[48:63]
    v_lshlrev_b32 v24, 16, v28
    v_and_b32 v25, 0xffff0000, v28
    v_mul_f32 v24, v15, v24
    v_mul_f32 v25, v15, v25
    s_waitcnt vmcnt(3)
    v_mfma_f32_32x32x16_bf16 v[32:47], v[216:219], v[108:111], v[32:47]
    buffer_load_dwordx4 v[124:127], v13, s[56:59], s87 offen offset:2048 sc1
    v_mfma_f32_32x32x16_bf16 v[48:63], v[220:223], v[108:111], v[48:63]
    v_lshlrev_b32 v26, 16, v29
    v_and_b32 v27, 0xffff0000, v29
    v_mul_f32 v26, v15, v26
    v_mul_f32 v27, v15, v27
    s_waitcnt vmcnt(3) lgkmcnt(12)
    v_mfma_f32_32x32x16_bf16 v[32:47], v[224:227], v[112:115], v[32:47]
    v_mfma_f32_32x32x16_bf16 v[48:63], v[228:231], v[112:115], v[48:63]
    v_lshlrev_b32 v28, 16, v30
    v_and_b32 v29, 0xffff0000, v30
    v_mul_f32 v28, v15, v28
    v_mul_f32 v29, v15, v29
    s_waitcnt vmcnt(2) lgkmcnt(8)
    v_mfma_f32_32x32x16_bf16 v[32:47], v[232:235], v[116:119], v[32:47]
    v_mfma_f32_32x32x16_bf16 v[48:63], v[236:239], v[116:119], v[48:63]
    v_lshlrev_b32 v30, 16, v31
    v_and_b32 v31, 0xffff0000, v31
    v_mul_f32 v30, v15, v30
    v_mul_f32 v31, v15, v31
    s_waitcnt vmcnt(1) lgkmcnt(4)
    v_mfma_f32_32x32x16_bf16 v[32:47], v[240:243], v[120:123], v[32:47]
    v_mfma_f32_32x32x16_bf16 v[48:63], v[244:247], v[120:123], v[48:63]
    s_waitcnt vmcnt(0) lgkmcnt(0)
    v_mfma_f32_32x32x16_bf16 v[32:47], v[248:251], v[124:127], v[32:47]
    v_mfma_f32_32x32x16_bf16 v[48:63], v[252:255], v[124:127], v[48:63]
    s_nop 10
    ds_write_b128 v7, v[32:35] offset:0
    ds_write_b128 v7, v[36:39] offset:1024
    ds_write_b128 v7, v[40:43] offset:2048
    ds_write_b128 v7, v[44:47] offset:3072
    s_waitcnt lgkmcnt(0)
    s_barrier
    ds_read_b128 v[32:35], v8 offset:0
    ds_read_b128 v[36:39], v8 offset:1024
    ds_read_b128 v[40:43], v8 offset:2048
    ds_read_b128 v[44:47], v8 offset:3072
    v_pk_fma_f32 v[16:17], v[48:49], v[10:11], v[16:17] op_sel_hi:[1,0,1]
    v_pk_fma_f32 v[18:19], v[50:51], v[10:11], v[18:19] op_sel_hi:[1,0,1]
    v_pk_fma_f32 v[20:21], v[52:53], v[10:11], v[20:21] op_sel_hi:[1,0,1]
    v_pk_fma_f32 v[22:23], v[54:55], v[10:11], v[22:23] op_sel_hi:[1,0,1]
    v_pk_fma_f32 v[24:25], v[56:57], v[10:11], v[24:25] op_sel_hi:[1,0,1]
    v_pk_fma_f32 v[26:27], v[58:59], v[10:11], v[26:27] op_sel_hi:[1,0,1]
    v_pk_fma_f32 v[28:29], v[60:61], v[10:11], v[28:29] op_sel_hi:[1,0,1]
    v_pk_fma_f32 v[30:31], v[62:63], v[10:11], v[30:31] op_sel_hi:[1,0,1]
    s_not_b64 vcc, s[10:11]
    s_waitcnt lgkmcnt(3)
    v_pk_fma_f32 v[16:17], v[32:33], v[10:11], v[16:17] op_sel_hi:[1,0,1]
    v_pk_fma_f32 v[18:19], v[34:35], v[10:11], v[18:19] op_sel_hi:[1,0,1]
    v_cvt_pk_bf16_f32 v64, v16, v17
    v_cvt_pk_bf16_f32 v65, v18, v19
    s_waitcnt lgkmcnt(2)
    v_pk_fma_f32 v[20:21], v[36:37], v[10:11], v[20:21] op_sel_hi:[1,0,1]
    v_pk_fma_f32 v[22:23], v[38:39], v[10:11], v[22:23] op_sel_hi:[1,0,1]
    v_cvt_pk_bf16_f32 v66, v20, v21
    v_cvt_pk_bf16_f32 v67, v22, v23
    s_waitcnt lgkmcnt(1)
    v_pk_fma_f32 v[24:25], v[40:41], v[10:11], v[24:25] op_sel_hi:[1,0,1]
    v_pk_fma_f32 v[26:27], v[42:43], v[10:11], v[26:27] op_sel_hi:[1,0,1]
    v_cvt_pk_bf16_f32 v68, v24, v25
    v_cvt_pk_bf16_f32 v69, v26, v27
    s_waitcnt lgkmcnt(0)
    v_pk_fma_f32 v[28:29], v[44:45], v[10:11], v[28:29] op_sel_hi:[1,0,1]
    v_pk_fma_f32 v[30:31], v[46:47], v[10:11], v[30:31] op_sel_hi:[1,0,1]
    v_cvt_pk_bf16_f32 v70, v28, v29
    v_cvt_pk_bf16_f32 v71, v30, v31
    v_cndmask_b32_dpp v72, v68, v64, vcc quad_perm:[1,0,3,2] row_mask:0xf bank_mask:0xf
    v_cndmask_b32_dpp v73, v69, v65, vcc quad_perm:[1,0,3,2] row_mask:0xf bank_mask:0xf
    v_cndmask_b32_dpp v74, v70, v66, vcc quad_perm:[1,0,3,2] row_mask:0xf bank_mask:0xf
    v_cndmask_b32_dpp v75, v71, v67, vcc quad_perm:[1,0,3,2] row_mask:0xf bank_mask:0xf
    buffer_store_dwordx4 v[72:75], v9, s[64:67], s100 offen nt
    s_mov_b64 vcc, s[10:11]
    v_cndmask_b32_dpp v76, v64, v68, vcc quad_perm:[1,0,3,2] row_mask:0xf bank_mask:0xf
    v_cndmask_b32_dpp v77, v65, v69, vcc quad_perm:[1,0,3,2] row_mask:0xf bank_mask:0xf
    v_cndmask_b32_dpp v78, v66, v70, vcc quad_perm:[1,0,3,2] row_mask:0xf bank_mask:0xf
    v_cndmask_b32_dpp v79, v67, v71, vcc quad_perm:[1,0,3,2] row_mask:0xf bank_mask:0xf
    buffer_store_dwordx4 v[76:79], v9, s[64:67], s100 offen offset:1024 nt
    s_or_b32 s8, s7, s3
    s_cbranch_scc1 L_notag_56
    s_mov_b32 s8, 11018240
    s_mov_b64 exec, 1
    v_mov_b32 v1, s96
    buffer_store_dword v1, off, s[56:59], s8 sc1
    s_mov_b64 exec, -1
L_notag_56:
    s_endpgm
L_tail_b:
    s_waitcnt vmcnt(0)
    s_mov_b64 exec, 1
    v_mov_b32 v1, s96
    s_cmp_lg_u32 s90, 0
    s_cbranch_scc1 L_el_57
    buffer_store_dword v1, off, s[56:59], s78
    s_branch L_fi_58
L_el_57:
    buffer_store_dword v1, off, s[56:59], s78 sc1
L_fi_58:
    s_mov_b64 exec, -1
    s_endpgm
L_side_slow:
    s_mov_b32 s8, 400000
L_side_lp:
    s_sleep 4
    buffer_load_dwordx2 v[236:237], v232, s[56:59], s75 offen sc1
    buffer_load_dwordx2 v[238:239], v233, s[56:59], 0 offen sc1
    s_waitcnt vmcnt(0)
    v_cmp_ne_u32 vcc, s96, v236
    v_cmp_ne_u32 s[92:93], s96, v237
    v_cmp_ne_u32 s[10:11], s96, v238
    s_nop 0
    s_or_b64 vcc, vcc, s[92:93]
    s_or_b64 vcc, vcc, s[10:11]
    s_cbranch_vccz L_side_ok
    s_sub_u32 s8, s8, 1
    s_cmp_lg_u32 s8, 0
    s_cbranch_scc1 L_side_lp
    s_branch L_side_ok
L_fallback:
    s_cmp_lg_u32 s15, 0
    s_cbranch_scc1 L_checked
    s_mov_b32 s15, 1
    s_mov_b32 s83, s84
    s_mov_b32 s8, 64
    v_mov_b32 v1, 0xff800000
L_fb1:
    buffer_load_dwordx4 v[112:115], v13, s[56:59], s83 offen sc1
    s_waitcnt vmcnt(0)
    v_mfma_f32_32x32x16_bf16 v[32:47], v[112:115], v[152:155], 0
    s_nop 11
    v_max3_f32 v1, v1, v32, v33
    v_max3_f32 v1, v1, v34, v35
    v_max3_f32 v1, v1, v36, v37
    v_max3_f32 v1, v1, v38, v39
    v_max3_f32 v1, v1, v40, v41
    v_max3_f32 v1, v1, v42, v43
    v_max3_f32 v1, v1, v44, v45
    v_max3_f32 v1, v1, v46, v47
    s_add_u32 s83, s83, 2048
    s_sub_u32 s8, s8, 1
    s_cmp_lg_u32 s8, 0
    s_cbranch_scc1 L_fb1
    v_mov_b32 v2, v1
    s_nop 1
    v_permlane32_swap_b32 v1, v2
    v_max_f32 v1, v1, v2
    v_sub_f32 v48, 0, v1
    v_sub_f32 v49, 0, v1
    v_sub_f32 v50, 0, v1
    v_sub_f32 v51, 0, v1
    v_sub_f32 v52, 0, v1
    v_sub_f32 v53, 0, v1
    v_sub_f32 v54, 0, v1
    v_sub_f32 v55, 0, v1
    v_sub_f32 v56, 0, v1
    v_sub_f32 v57, 0, v1
    v_sub_f32 v58, 0, v1
    v_sub_f32 v59, 0, v1
    v_sub_f32 v60, 0, v1
    v_sub_f32 v61, 0, v1
    v_sub_f32 v62, 0, v1
    v_sub_f32 v63, 0, v1
    v_mov_b32 v96, 0
    v_mov_b32 v97, 0
    v_mov_b32 v98, 0
    v_mov_b32 v99, 0
    v_mov_b32 v100, 0
    v_mov_b32 v101, 0
    v_mov_b32 v102, 0
    v_mov_b32 v103, 0
    v_mov_b32 v104, 0
    v_mov_b32 v105, 0
    v_mov_b32 v106, 0
    v_mov_b32 v107, 0
    v_mov_b32 v108, 0
    v_mov_b32 v109, 0
    v_mov_b32 v110, 0
    v_mov_b32 v111, 0
    s_mov_b32 s83, s84
    s_mov_b32 s8, 64
L_fb2:
    buffer_load_dwordx4 v[112:115], v13, s[56:59], s83 offen sc1
    s_mov_b64 exec, s[88:89]
    buffer_load_dwordx4 v[116:119], v14, s[56:59], s83 offen offset:1024 sc1
    buffer_load_dwordx4 v[120:123], v14, s[56:59], s83 offen offset:1536 sc1
    s_mov_b64 exec, -1
    s_waitcnt vmcnt(0)
    v_mfma_f32_32x32x16_bf16 v[32:47], v[112:115], v[152:155], v[48:63]
    s_nop 11
    v_exp_f32 v32, v32
    v_exp_f32 v33, v33
    v_exp_f32 v34, v34
    v_exp_f32 v35, v35
    v_exp_f32 v36, v36
    v_exp_f32 v37, v37
    v_exp_f32 v38, v38
    v_exp_f32 v39, v39
    v_exp_f32 v40, v40
    v_exp_f32 v41, v41
    v_exp_f32 v42, v42
    v_exp_f32 v43, v43
    v_exp_f32 v44, v44
    v_exp_f32 v45, v45
    v_exp_f32 v46, v46
    v_exp_f32 v47, v47
    v_smfmac_f32_32x32x32_bf16 v[96:111], v[116:119], v[32:39], v12
    s_nop 0
    v_smfmac_f32_32x32x32_bf16 v[96:111], v[120:123], v[40:47], v12
    s_add_u32 s83, s83, 2048
    s_sub_u32 s8, s8, 1
    s_cmp_lg_u32 s8, 0
    s_cbranch_scc1 L_fb2
    s_nop 15
    s_branch L_norm
L_end:
    s_endpgm
.section .rodata,"a"
.p2align 6
.amdhsa_kernel gated_mix__ssm_conv_s4__mha_block__prompt_kernel
  .amdhsa_next_free_vgpr 256
  .amdhsa_next_free_sgpr 102
  .amdhsa_accum_offset 256
  .amdhsa_group_segment_fixed_size 0
  .amdhsa_kernarg_size 128
  .amdhsa_user_sgpr_count 2
  .amdhsa_user_sgpr_kernarg_segment_ptr 1
  .amdhsa_system_sgpr_workgroup_id_x 1
.end_amdhsa_kernel
```
